```python
import torch

def _softmax(x, axis=-1):
    return torch.softmax(x, dim=axis)

def _gelu(x):
    return torch.nn.functional.gelu(x, approximate='tanh')

def _silu(x):
    return torch.nn.functional.silu(x)

def _sigmoid(x):
    return torch.sigmoid(x)

def _layernorm(x, axis=-1, eps=1e-05):
    m = x.mean(dim=axis, keepdim=True)
    v = x.var(dim=axis, keepdim=True, unbiased=False)
    return (x - m) / torch.sqrt(v + eps)

def _scatter_add(tgt, idx, src, axis=0):
    return tgt.clone().index_add_(axis, idx, src)

def _segment_sum(src, seg, n):
    out = torch.zeros((n,) + src.shape[1:], dtype=src.dtype)
    return out.index_add_(0, seg, src)

def _pad(x, pw):
    flat = tuple((v for pair in reversed(pw) for v in pair))
    return torch.nn.functional.pad(x, flat)
kernel_name = 'adaLN_cond__mha_block__dense_activation_relu__prompt'

def setup_inputs():

    _w = lambda a: (lambda t: t.to(torch.bfloat16) if t.is_floating_point() else t)(torch.as_tensor(a))

    def _A_setup():
        B, S, D, H = (1, 2048, 1024, 32)
        return {'x': _w((lambda *s: torch.randn(*s, dtype=torch.bfloat16) * 0.05)(B, S, D)), 'wqkv': _w((lambda *s: torch.randn(*s, dtype=torch.bfloat16) * 0.05)(D, 3 * D)), 'wo': _w((lambda *s: torch.randn(*s, dtype=torch.bfloat16) * 0.05)(D, D))}
    _A_in = _A_setup()

    def _B_setup():
        B, S, D, Dff = (1, 2048, 1024, 3584)
        return {'x': _w((lambda *s: torch.randn(*s, dtype=torch.bfloat16) * 0.05)(B, S, D)), 'w1': _w((lambda *s: torch.randn(*s, dtype=torch.bfloat16) * 0.05)(D, Dff)), 'w2': _w((lambda *s: torch.randn(*s, dtype=torch.bfloat16) * 0.05)(Dff, D))}
    _B_in = _B_setup()
    return {'A_x': _A_in['x'], 'A_wqkv': _A_in['wqkv'], 'A_wo': _A_in['wo'], 'B_x': _B_in['x'], 'B_w1': _B_in['w1'], 'B_w2': _B_in['w2'], 'c': _w((lambda *s: torch.randn(*s, dtype=torch.bfloat16) * 0.2)(1, 1024) * 8.0), 'w_mod': _w((lambda *s: torch.randn(*s, dtype=torch.bfloat16) * 0.2)(1024, 6 * 1024) * 1024 ** (-0.5) * 8.0)}

def reference(A_x, A_wqkv, A_wo, B_x, B_w1, B_w2, c, w_mod):

    def _A_ref(x, wqkv, wo):
        B, S, D = x.shape
        H = 32
        Dh = D // H
        qkv = (lambda x, *d: x.permute(*d))((x @ wqkv).reshape(B, S, 3, H, Dh), 2, 0, 3, 1, 4)
        q, k, v = (qkv[0], qkv[1], qkv[2])
        scores = torch.einsum('bhqd,bhkd->bhqk', q, k) * Dh ** (-0.5)
        p = _softmax(scores, axis=-1)
        o = torch.einsum('bhqk,bhkd->bhqd', p, v)
        return (lambda x, *d: x.permute(*d))(o, 0, 2, 1, 3).reshape(B, S, D) @ wo

    def _B_ref(x, w1, w2):
        h = torch.einsum('bsd,df->bsf', x, w1)
        zero = torch.zeros_like(h)
        h = torch.maximum(h, zero)
        return torch.einsum('bsf,fd->bsd', h, w2)
    x = A_x
    mod = (_silu(c) @ w_mod).reshape(c.shape[0], 6, 1, -1)
    sa, ca, ga, sb, cb, gb = (mod[:, 0].clone(), mod[:, 1].clone(), mod[:, 2].clone(), mod[:, 3].clone(), mod[:, 4].clone(), mod[:, 5].clone())
    h = _layernorm(x, axis=-1) * (1 + ca) + sa
    x = x + ga * _A_ref(h, A_wqkv, A_wo)
    h = _layernorm(x, axis=-1) * (1 + cb) + sb
    x = x + gb * _B_ref(h, B_w1, B_w2)
    return x
```

```asm
; @launch kernel=mod_kernel grid=(256,1,1) block=(256,1,1) lds=69632
; @launch kernel=lnq_kernel grid=(256,1,1) block=(256,1,1) lds=100352
; @launch kernel=amega_kernel grid=(256,1,1) block=(256,1,1) lds=139264
.amdgcn_target "amdgcn-amd-amdhsa--gfx950"
.text
.globl mod_kernel
.p2align 8
.type mod_kernel,@function
mod_kernel:
    s_cmp_ge_u32 s2, 256
    s_cbranch_scc1 END_1
    s_cmp_ge_u32 s2, 192
    s_cbranch_scc1 PF_2
    s_load_dwordx2 s[4:5], s[0:1], 80
    s_load_dwordx2 s[6:7], s[0:1], 56
    s_load_dwordx2 s[20:21], s[0:1], 48
    v_lshrrev_b32 v1, 6, v0
    s_lshr_b32 s23, s2, 1
    v_readfirstlane_b32 s22, v1
    s_and_b32 s24, s2, 1
    v_and_b32 v1, 63, v0
    v_lshrrev_b32 v13, 3, v1
    v_bfe_u32 v14, v1, 4, 1
    v_lshlrev_b32 v14, 2, v14
    v_and_b32 v12, 7, v1
    v_xor_b32 v12, v12, v14
    v_lshlrev_b32 v12, 4, v12
    v_mul_u32_u24 v13, 12288, v13
    v_add_u32 v12, v12, v13
    s_lshl_b32 s25, s24, 9
    s_lshl_b32 s26, s22, 7
    s_add_u32 s25, s25, s26
    s_mul_i32 s25, s25, 12288
    s_lshl_b32 s26, s23, 7
    s_add_u32 s25, s25, s26
    s_lshl_b32 s27, s22, 14
    s_add_u32 s27, s27, 4096
    v_lshlrev_b32 v2, 2, v0
    s_lshl_b32 s28, s24, 10
    s_waitcnt lgkmcnt(0)
    s_mov_b32 s8, s6
    s_and_b32 s9, s7, 0xffff
    s_mov_b32 s10, 12582912
    s_mov_b32 s11, 0x20000
    s_mov_b32 s12, s20
    s_and_b32 s13, s21, 0xffff
    s_mov_b32 s14, 2048
    s_mov_b32 s15, 0x20000
    buffer_load_dword v4, v2, s[12:15], s28 offen
    s_add_u32 m0, s27, 0
    s_nop 0
    buffer_load_dwordx4 v12, s[8:11], s25 offen nt lds
    s_add_u32 s25, s25, 98304
    s_add_u32 m0, s27, 1024
    s_nop 0
    buffer_load_dwordx4 v12, s[8:11], s25 offen nt lds
    s_add_u32 s25, s25, 98304
    s_add_u32 m0, s27, 2048
    s_nop 0
    buffer_load_dwordx4 v12, s[8:11], s25 offen nt lds
    s_add_u32 s25, s25, 98304
    s_add_u32 m0, s27, 3072
    s_nop 0
    buffer_load_dwordx4 v12, s[8:11], s25 offen nt lds
    s_add_u32 s25, s25, 98304
    s_add_u32 m0, s27, 4096
    s_nop 0
    buffer_load_dwordx4 v12, s[8:11], s25 offen nt lds
    s_add_u32 s25, s25, 98304
    s_add_u32 m0, s27, 5120
    s_nop 0
    buffer_load_dwordx4 v12, s[8:11], s25 offen nt lds
    s_add_u32 s25, s25, 98304
    s_add_u32 m0, s27, 6144
    s_nop 0
    buffer_load_dwordx4 v12, s[8:11], s25 offen nt lds
    s_add_u32 s25, s25, 98304
    s_add_u32 m0, s27, 7168
    s_nop 0
    buffer_load_dwordx4 v12, s[8:11], s25 offen nt lds
    s_add_u32 s25, s25, 98304
    s_add_u32 m0, s27, 8192
    s_nop 0
    buffer_load_dwordx4 v12, s[8:11], s25 offen nt lds
    s_add_u32 s25, s25, 98304
    s_add_u32 m0, s27, 9216
    s_nop 0
    buffer_load_dwordx4 v12, s[8:11], s25 offen nt lds
    s_add_u32 s25, s25, 98304
    s_add_u32 m0, s27, 10240
    s_nop 0
    buffer_load_dwordx4 v12, s[8:11], s25 offen nt lds
    s_add_u32 s25, s25, 98304
    s_add_u32 m0, s27, 11264
    s_nop 0
    buffer_load_dwordx4 v12, s[8:11], s25 offen nt lds
    s_add_u32 s25, s25, 98304
    s_add_u32 m0, s27, 12288
    s_nop 0
    buffer_load_dwordx4 v12, s[8:11], s25 offen nt lds
    s_add_u32 s25, s25, 98304
    s_add_u32 m0, s27, 13312
    s_nop 0
    buffer_load_dwordx4 v12, s[8:11], s25 offen nt lds
    s_add_u32 s25, s25, 98304
    s_add_u32 m0, s27, 14336
    s_nop 0
    buffer_load_dwordx4 v12, s[8:11], s25 offen nt lds
    s_add_u32 s25, s25, 98304
    s_add_u32 m0, s27, 15360
    s_nop 0
    buffer_load_dwordx4 v12, s[8:11], s25 offen nt lds
    s_add_u32 s16, s4, 524288
    s_addc_u32 s17, s5, 0
    s_and_b32 s17, s17, 0xffff
    s_mov_b32 s18, 49152
    s_mov_b32 s19, 0x20000
    s_mov_b32 s30, 0xffff0000
    v_lshrrev_b32 v13, 5, v1
    v_lshlrev_b32 v13, 2, v13
    v_bfe_u32 v14, v1, 2, 2
    v_add_u32 v13, v13, v14
    v_lshlrev_b32 v13, 7, v13
    v_bfe_u32 v14, v1, 4, 1
    v_lshlrev_b32 v14, 1, v14
    v_bfe_u32 v15, v1, 1, 1
    v_add_u32 v14, v14, v15
    v_bfe_u32 v15, v1, 3, 1
    v_lshlrev_b32 v15, 2, v15
    v_xor_b32 v14, v14, v15
    v_lshlrev_b32 v14, 4, v14
    v_add_u32 v13, v13, v14
    v_and_b32 v15, 1, v1
    v_lshlrev_b32 v15, 3, v15
    v_add_u32 v22, v13, v15
    v_xor_b32 v23, 64, v22
    v_add_u32 v22, s27, v22
    v_add_u32 v23, s27, v23
    v_lshrrev_b32 v24, 5, v1
    v_lshlrev_b32 v24, 3, v24
    s_lshl_b32 s25, s22, 8
    v_add_u32 v24, s25, v24
    v_mov_b32 v32, 0
    v_mov_b32 v33, 0
    v_mov_b32 v34, 0
    v_mov_b32 v35, 0
    v_mov_b32 v36, 0
    v_mov_b32 v37, 0
    v_mov_b32 v38, 0
    v_mov_b32 v39, 0
    v_mov_b32 v40, 0
    v_mov_b32 v41, 0
    v_mov_b32 v42, 0
    v_mov_b32 v43, 0
    v_mov_b32 v44, 0
    v_mov_b32 v45, 0
    v_mov_b32 v46, 0
    v_mov_b32 v47, 0
    v_mov_b32 v48, 0
    v_mov_b32 v49, 0
    v_mov_b32 v50, 0
    v_mov_b32 v51, 0
    v_mov_b32 v52, 0
    v_mov_b32 v53, 0
    v_mov_b32 v54, 0
    v_mov_b32 v55, 0
    v_mov_b32 v56, 0
    v_mov_b32 v57, 0
    v_mov_b32 v58, 0
    v_mov_b32 v59, 0
    v_mov_b32 v60, 0
    v_mov_b32 v61, 0
    v_mov_b32 v62, 0
    v_mov_b32 v63, 0
    s_waitcnt vmcnt(16)
    v_lshlrev_b32 v6, 16, v4
    v_and_b32 v7, s30, v4
    v_mul_f32 v14, 0xbfb8aa3b, v6
    v_mul_f32 v15, 0xbfb8aa3b, v7
    v_exp_f32 v14, v14
    v_exp_f32 v15, v15
    s_nop 0
    v_add_f32 v14, 1.0, v14
    v_add_f32 v15, 1.0, v15
    v_rcp_f32 v14, v14
    v_rcp_f32 v15, v15
    s_nop 0
    v_mul_f32 v14, v6, v14
    v_mul_f32 v15, v7, v15
    v_cvt_pk_bf16_f32 v18, v14, v15
    ds_write_b32 v2, v18
    s_waitcnt lgkmcnt(0)
    ds_read_b64 v[64:65], v24 offset:0
    ds_read_b64 v[66:67], v24 offset:16
    ds_read_b64 v[68:69], v24 offset:32
    ds_read_b64 v[70:71], v24 offset:48
    ds_read_b64 v[72:73], v24 offset:64
    ds_read_b64 v[74:75], v24 offset:80
    ds_read_b64 v[76:77], v24 offset:96
    ds_read_b64 v[78:79], v24 offset:112
    ds_read_b64 v[80:81], v24 offset:128
    ds_read_b64 v[82:83], v24 offset:144
    ds_read_b64 v[84:85], v24 offset:160
    ds_read_b64 v[86:87], v24 offset:176
    ds_read_b64 v[88:89], v24 offset:192
    ds_read_b64 v[90:91], v24 offset:208
    ds_read_b64 v[92:93], v24 offset:224
    ds_read_b64 v[94:95], v24 offset:240
    s_waitcnt vmcnt(14)
    ds_read_b64_tr_b16 v[96:97], v22 offset:0
    ds_read_b64_tr_b16 v[98:99], v22 offset:1024
    ds_read_b64_tr_b16 v[100:101], v23 offset:0
    ds_read_b64_tr_b16 v[102:103], v23 offset:1024
    s_waitcnt lgkmcnt(0)
    v_mfma_f32_32x32x16_bf16 v[32:47], v[96:99], v[64:67], v[32:47]
    v_mfma_f32_32x32x16_bf16 v[48:63], v[100:103], v[64:67], v[48:63]
    s_waitcnt vmcnt(12)
    ds_read_b64_tr_b16 v[104:105], v22 offset:2048
    ds_read_b64_tr_b16 v[106:107], v22 offset:3072
    ds_read_b64_tr_b16 v[108:109], v23 offset:2048
    ds_read_b64_tr_b16 v[110:111], v23 offset:3072
    s_waitcnt lgkmcnt(0)
    v_mfma_f32_32x32x16_bf16 v[32:47], v[104:107], v[68:71], v[32:47]
    v_mfma_f32_32x32x16_bf16 v[48:63], v[108:111], v[68:71], v[48:63]
    s_waitcnt vmcnt(10)
    ds_read_b64_tr_b16 v[96:97], v22 offset:4096
    ds_read_b64_tr_b16 v[98:99], v22 offset:5120
    ds_read_b64_tr_b16 v[100:101], v23 offset:4096
    ds_read_b64_tr_b16 v[102:103], v23 offset:5120
    s_waitcnt lgkmcnt(0)
    v_mfma_f32_32x32x16_bf16 v[32:47], v[96:99], v[72:75], v[32:47]
    v_mfma_f32_32x32x16_bf16 v[48:63], v[100:103], v[72:75], v[48:63]
    s_waitcnt vmcnt(8)
    ds_read_b64_tr_b16 v[104:105], v22 offset:6144
    ds_read_b64_tr_b16 v[106:107], v22 offset:7168
    ds_read_b64_tr_b16 v[108:109], v23 offset:6144
    ds_read_b64_tr_b16 v[110:111], v23 offset:7168
    s_waitcnt lgkmcnt(0)
    v_mfma_f32_32x32x16_bf16 v[32:47], v[104:107], v[76:79], v[32:47]
    v_mfma_f32_32x32x16_bf16 v[48:63], v[108:111], v[76:79], v[48:63]
    s_waitcnt vmcnt(6)
    ds_read_b64_tr_b16 v[96:97], v22 offset:8192
    ds_read_b64_tr_b16 v[98:99], v22 offset:9216
    ds_read_b64_tr_b16 v[100:101], v23 offset:8192
    ds_read_b64_tr_b16 v[102:103], v23 offset:9216
    s_waitcnt lgkmcnt(0)
    v_mfma_f32_32x32x16_bf16 v[32:47], v[96:99], v[80:83], v[32:47]
    v_mfma_f32_32x32x16_bf16 v[48:63], v[100:103], v[80:83], v[48:63]
    s_waitcnt vmcnt(4)
    ds_read_b64_tr_b16 v[104:105], v22 offset:10240
    ds_read_b64_tr_b16 v[106:107], v22 offset:11264
    ds_read_b64_tr_b16 v[108:109], v23 offset:10240
    ds_read_b64_tr_b16 v[110:111], v23 offset:11264
    s_waitcnt lgkmcnt(0)
    v_mfma_f32_32x32x16_bf16 v[32:47], v[104:107], v[84:87], v[32:47]
    v_mfma_f32_32x32x16_bf16 v[48:63], v[108:111], v[84:87], v[48:63]
    s_waitcnt vmcnt(2)
    ds_read_b64_tr_b16 v[96:97], v22 offset:12288
    ds_read_b64_tr_b16 v[98:99], v22 offset:13312
    ds_read_b64_tr_b16 v[100:101], v23 offset:12288
    ds_read_b64_tr_b16 v[102:103], v23 offset:13312
    s_waitcnt lgkmcnt(0)
    v_mfma_f32_32x32x16_bf16 v[32:47], v[96:99], v[88:91], v[32:47]
    v_mfma_f32_32x32x16_bf16 v[48:63], v[100:103], v[88:91], v[48:63]
    s_waitcnt vmcnt(0)
    ds_read_b64_tr_b16 v[104:105], v22 offset:14336
    ds_read_b64_tr_b16 v[106:107], v22 offset:15360
    ds_read_b64_tr_b16 v[108:109], v23 offset:14336
    ds_read_b64_tr_b16 v[110:111], v23 offset:15360
    s_waitcnt lgkmcnt(0)
    v_mfma_f32_32x32x16_bf16 v[32:47], v[104:107], v[92:95], v[32:47]
    v_mfma_f32_32x32x16_bf16 v[48:63], v[108:111], v[92:95], v[48:63]
    v_and_b32 v2, 31, v1
    v_lshrrev_b32 v3, 5, v1
    v_lshlrev_b32 v3, 4, v3
    s_lshl_b32 s25, s22, 8
    s_add_u32 s25, s25, 1024
    v_add_u32 v3, s25, v3
    v_cmp_eq_u32 vcc, 0, v2
    s_nop 7
    s_and_saveexec_b64 s[26:27], vcc
    ds_write_b128 v3, v[32:35] offset:0
    ds_write_b128 v3, v[36:39] offset:32
    ds_write_b128 v3, v[40:43] offset:64
    ds_write_b128 v3, v[44:47] offset:96
    ds_write_b128 v3, v[48:51] offset:128
    ds_write_b128 v3, v[52:55] offset:160
    ds_write_b128 v3, v[56:59] offset:192
    ds_write_b128 v3, v[60:63] offset:224
    s_mov_b64 exec, s[26:27]
    s_waitcnt lgkmcnt(0)
    s_barrier
    v_cmp_gt_u32 vcc, 64, v0
    s_and_saveexec_b64 s[26:27], vcc
    s_cbranch_execz END_1
    v_lshlrev_b32 v2, 2, v0
    ds_read_b32 v4, v2 offset:1024
    ds_read_b32 v5, v2 offset:1280
    ds_read_b32 v6, v2 offset:1536
    ds_read_b32 v7, v2 offset:1792
    s_mul_i32 s25, s24, 24576
    s_lshl_b32 s26, s23, 8
    s_add_u32 s25, s25, s26
    s_waitcnt lgkmcnt(0)
    v_add_f32 v4, v4, v5
    v_add_f32 v6, v6, v7
    v_add_f32 v4, v4, v6
    buffer_store_dword v4, v2, s[16:19], s25 offen
    s_endpgm
PF_2:
    s_load_dwordx2 s[4:5], s[0:1], 0
    s_load_dwordx2 s[6:7], s[0:1], 80
    s_sub_u32 s20, s2, 192
    v_lshlrev_b32 v1, 4, v0
    s_lshl_b32 s21, s20, 16
    s_waitcnt lgkmcnt(0)
    s_getpc_b64 s[24:25]
PC_3:
    s_sub_u32 s24, s24, PC_3-mod_kernel
    s_subb_u32 s25, s25, 0
    s_lshl_b32 s26, s20, 12
    v_add_u32 v90, s26, v1
    v_cmp_gt_u32 vcc, CODE_END-mod_kernel-16, v90
    v_mov_b32 v93, s25
    v_add_co_u32 v92, s[28:29], s24, v90
    s_nop 1
    v_addc_co_u32 v93, s[28:29], 0, v93, s[28:29]
    s_and_saveexec_b64 s[30:31], vcc
    s_cbranch_execz NOCP_4
    global_load_dwordx4 v[96:99], v[92:93], off
NOCP_4:
    s_mov_b64 exec, s[30:31]
    s_mov_b32 s8, s4
    s_and_b32 s9, s5, 0xffff
    s_mov_b32 s10, 4194304
    s_mov_b32 s11, 0x20000
    s_add_u32 s12, s6, 655360
    s_addc_u32 s13, s7, 0
    s_and_b32 s13, s13, 0xffff
    s_mov_b32 s14, 262144
    s_mov_b32 s15, 0x20000
    v_mov_b32 v80, 0
    v_mov_b32 v81, 0
    v_mov_b32 v82, 0
    v_mov_b32 v83, 0
    s_lshl_b32 s22, s20, 12
    buffer_store_dwordx4 v[80:83], v1, s[12:15], s22 offen
    buffer_load_dwordx4 v[4:7], v1, s[8:11], s21 offen
    s_add_u32 s21, s21, 4096
    buffer_load_dwordx4 v[8:11], v1, s[8:11], s21 offen
    s_add_u32 s21, s21, 4096
    buffer_load_dwordx4 v[12:15], v1, s[8:11], s21 offen
    s_add_u32 s21, s21, 4096
    buffer_load_dwordx4 v[16:19], v1, s[8:11], s21 offen
    s_add_u32 s21, s21, 4096
    buffer_load_dwordx4 v[20:23], v1, s[8:11], s21 offen
    s_add_u32 s21, s21, 4096
    buffer_load_dwordx4 v[24:27], v1, s[8:11], s21 offen
    s_add_u32 s21, s21, 4096
    buffer_load_dwordx4 v[28:31], v1, s[8:11], s21 offen
    s_add_u32 s21, s21, 4096
    buffer_load_dwordx4 v[32:35], v1, s[8:11], s21 offen
    s_add_u32 s21, s21, 4096
    buffer_load_dwordx4 v[36:39], v1, s[8:11], s21 offen
    s_add_u32 s21, s21, 4096
    buffer_load_dwordx4 v[40:43], v1, s[8:11], s21 offen
    s_add_u32 s21, s21, 4096
    buffer_load_dwordx4 v[44:47], v1, s[8:11], s21 offen
    s_add_u32 s21, s21, 4096
    buffer_load_dwordx4 v[48:51], v1, s[8:11], s21 offen
    s_add_u32 s21, s21, 4096
    buffer_load_dwordx4 v[52:55], v1, s[8:11], s21 offen
    s_add_u32 s21, s21, 4096
    buffer_load_dwordx4 v[56:59], v1, s[8:11], s21 offen
    s_add_u32 s21, s21, 4096
    buffer_load_dwordx4 v[60:63], v1, s[8:11], s21 offen
    s_add_u32 s21, s21, 4096
    buffer_load_dwordx4 v[64:67], v1, s[8:11], s21 offen
    s_add_u32 s21, s21, 4096
    s_waitcnt vmcnt(0)
END_1:
    s_endpgm
.globl lnq_kernel
.p2align 8
.type lnq_kernel,@function
lnq_kernel:
    s_cmp_ge_u32 s2, 256
    s_cbranch_scc1 END_5
    s_load_dwordx2 s[4:5], s[0:1], 80
    s_load_dwordx2 s[6:7], s[0:1], 0
    s_load_dwordx2 s[34:35], s[0:1], 8
    s_load_dwordx2 s[32:33], s[0:1], 16
    s_cmp_ge_u32 s2, 64
    s_cbranch_scc1 NOSCP_8
    s_getpc_b64 s[96:97]
PC_7:
    s_sub_u32 s96, s96, PC_7-lnq_kernel
    s_subb_u32 s97, s97, 0
    s_lshr_b32 s98, s2, 3
    s_lshl_b32 s98, s98, 12
    v_lshlrev_b32 v126, 4, v0
    v_add_u32 v126, s98, v126
    v_cmp_gt_u32 vcc, END_5-lnq_kernel-16, v126
    v_mov_b32 v125, s97
    v_add_co_u32 v124, s[98:99], s96, v126
    s_nop 1
    v_addc_co_u32 v125, s[98:99], 0, v125, s[98:99]
    s_and_saveexec_b64 s[98:99], vcc
    s_cbranch_execz NOSCP_8x
    global_load_dwordx4 v[120:123], v[124:125], off
NOSCP_8x:
    s_mov_b64 exec, s[98:99]
NOSCP_8:
    v_lshrrev_b32 v1, 6, v0
    s_lshl_b32 s23, s2, 3
    v_readfirstlane_b32 s22, v1
    v_and_b32 v1, 63, v0
    v_and_b32 v2, 7, v1
    v_lshrrev_b32 v3, 3, v1
    s_lshl_b32 s24, s22, 4
    v_add_u32 v3, s24, v3
    v_add_u32 v4, s23, v2
    v_lshlrev_b32 v5, 11, v4
    v_lshlrev_b32 v6, 5, v3
    v_add_u32 v5, v5, v6
    v_lshlrev_b32 v7, 4, v0
    s_waitcnt lgkmcnt(0)
    s_mov_b32 s8, s6
    s_and_b32 s9, s7, 0xffff
    s_mov_b32 s10, 4194304
    s_mov_b32 s11, 0x20000
    s_add_u32 s12, s4, 524288
    s_addc_u32 s13, s5, 0
    s_and_b32 s13, s13, 0xffff
    s_mov_b32 s14, 49152
    s_mov_b32 s15, 0x20000
    buffer_load_dwordx4 v[8:11], v5, s[8:11], 0 offen
    buffer_load_dwordx4 v[12:15], v5, s[8:11], 0 offen offset:16
    buffer_load_dwordx4 v[16:19], v5, s[8:11], 0 offen offset:256
    buffer_load_dwordx4 v[20:23], v5, s[8:11], 0 offen offset:272
    s_mov_b32 s25, 24576
    s_mov_b32 s26, 4096
    s_add_u32 s28, s25, s26
    buffer_load_dwordx4 v[64:67], v7, s[12:15], 0 offen
    buffer_load_dwordx4 v[68:71], v7, s[12:15], s25 offen
    buffer_load_dwordx4 v[72:75], v7, s[12:15], s26 offen
    buffer_load_dwordx4 v[76:79], v7, s[12:15], s28 offen
    s_lshl_b32 s31, s2, 11
    s_add_u32 s31, s31, 8192
    s_add_u32 s28, s31, 24576
    buffer_load_dwordx4 v[128:131], v7, s[12:15], s31 offen
    buffer_load_dwordx4 v[132:135], v7, s[12:15], s28 offen
    s_mov_b32 s36, s34
    s_and_b32 s37, s35, 0xffff
    s_mov_b32 s38, 6291456
    s_mov_b32 s39, 0x20000
    s_mul_i32 s29, s2, 24576
    buffer_load_dwordx4 v[136:139], v7, s[36:39], s29 offen
    s_add_u32 s29, s29, 4096
    buffer_load_dwordx4 v[140:143], v7, s[36:39], s29 offen
    s_add_u32 s29, s29, 4096
    buffer_load_dwordx4 v[136:139], v7, s[36:39], s29 offen
    s_add_u32 s29, s29, 4096
    buffer_load_dwordx4 v[140:143], v7, s[36:39], s29 offen
    s_add_u32 s29, s29, 4096
    buffer_load_dwordx4 v[136:139], v7, s[36:39], s29 offen
    s_add_u32 s29, s29, 4096
    buffer_load_dwordx4 v[140:143], v7, s[36:39], s29 offen
    s_mov_b32 s36, s32
    s_and_b32 s37, s33, 0xffff
    s_mov_b32 s38, 2097152
    s_mov_b32 s39, 0x20000
    s_lshl_b32 s29, s2, 13
    buffer_load_dwordx4 v[144:147], v7, s[36:39], s29 offen
    s_add_u32 s29, s29, 4096
    buffer_load_dwordx4 v[148:151], v7, s[36:39], s29 offen
    s_add_u32 s16, s4, 1048576
    s_addc_u32 s17, s5, 0
    s_and_b32 s17, s17, 0xffff
    s_mov_b32 s18, 4194304
    s_mov_b32 s19, 0x20000
    s_mov_b32 s30, 0xffff0000
    v_lshrrev_b32 v6, 5, v4
    v_lshlrev_b32 v6, 16, v6
    v_and_b32 v25, 31, v4
    v_lshlrev_b32 v25, 4, v25
    v_add_u32 v6, v6, v25
    v_lshlrev_b32 v25, 10, v3
    v_add_u32 v6, v6, v25
    s_mov_b32 s35, 8192
    s_waitcnt vmcnt(14)
    v_lshlrev_b32 v32, 16, v8
    v_and_b32 v33, s30, v8
    v_lshlrev_b32 v34, 16, v9
    v_and_b32 v35, s30, v9
    v_lshlrev_b32 v36, 16, v10
    v_and_b32 v37, s30, v10
    v_lshlrev_b32 v38, 16, v11
    v_and_b32 v39, s30, v11
    v_lshlrev_b32 v40, 16, v12
    v_and_b32 v41, s30, v12
    v_lshlrev_b32 v42, 16, v13
    v_and_b32 v43, s30, v13
    v_lshlrev_b32 v44, 16, v14
    v_and_b32 v45, s30, v14
    v_lshlrev_b32 v46, 16, v15
    v_and_b32 v47, s30, v15
    v_lshlrev_b32 v48, 16, v16
    v_and_b32 v49, s30, v16
    v_lshlrev_b32 v50, 16, v17
    v_and_b32 v51, s30, v17
    v_lshlrev_b32 v52, 16, v18
    v_and_b32 v53, s30, v18
    v_lshlrev_b32 v54, 16, v19
    v_and_b32 v55, s30, v19
    v_lshlrev_b32 v56, 16, v20
    v_and_b32 v57, s30, v20
    v_lshlrev_b32 v58, 16, v21
    v_and_b32 v59, s30, v21
    v_lshlrev_b32 v60, 16, v22
    v_and_b32 v61, s30, v22
    v_lshlrev_b32 v62, 16, v23
    v_and_b32 v63, s30, v23
    v_swap_b32 v10, v12
    v_swap_b32 v11, v13
    v_swap_b32 v18, v20
    v_swap_b32 v19, v21
    s_nop 1
    buffer_store_dwordx4 v[8:11], v6, s[16:19], 0 offen sc1
    buffer_store_dwordx4 v[12:15], v6, s[16:19], 0 offen offset:512 sc1
    buffer_store_dwordx4 v[16:19], v6, s[16:19], s35 offen sc1
    buffer_store_dwordx4 v[20:23], v6, s[16:19], s35 offen offset:512 sc1
    s_waitcnt vmcnt(14)
    v_add_f32 v64, v64, v68
    v_add_f32 v72, v72, v76
    v_add_f32 v65, v65, v69
    v_add_f32 v73, v73, v77
    v_add_f32 v66, v66, v70
    v_add_f32 v74, v74, v78
    v_add_f32 v67, v67, v71
    v_add_f32 v75, v75, v79
    v_cvt_pk_bf16_f32 v25, v64, v65
    v_lshlrev_b32 v64, 16, v25
    v_and_b32 v65, s30, v25
    v_cvt_pk_bf16_f32 v25, v66, v67
    v_lshlrev_b32 v66, 16, v25
    v_and_b32 v67, s30, v25
    v_cvt_pk_bf16_f32 v25, v72, v73
    v_lshlrev_b32 v72, 16, v25
    v_and_b32 v73, s30, v25
    v_cvt_pk_bf16_f32 v25, v74, v75
    v_lshlrev_b32 v74, 16, v25
    v_and_b32 v75, s30, v25
    v_add_f32 v72, 1.0, v72
    v_add_f32 v73, 1.0, v73
    v_add_f32 v74, 1.0, v74
    v_add_f32 v75, 1.0, v75
    v_cvt_pk_bf16_f32 v25, v72, v73
    v_lshlrev_b32 v72, 16, v25
    v_and_b32 v73, s30, v25
    v_cvt_pk_bf16_f32 v25, v74, v75
    v_lshlrev_b32 v74, 16, v25
    v_and_b32 v75, s30, v25
    ds_write_b128 v7, v[64:67] offset:1024
    ds_write_b128 v7, v[72:75] offset:5120
    v_pk_add_f32 v[28:29], v[32:33], v[34:35]
    v_pk_add_f32 v[28:29], v[28:29], v[36:37]
    v_pk_add_f32 v[28:29], v[28:29], v[38:39]
    v_pk_add_f32 v[28:29], v[28:29], v[40:41]
    v_pk_add_f32 v[28:29], v[28:29], v[42:43]
    v_pk_add_f32 v[28:29], v[28:29], v[44:45]
    v_pk_add_f32 v[28:29], v[28:29], v[46:47]
    v_pk_add_f32 v[28:29], v[28:29], v[48:49]
    v_pk_add_f32 v[28:29], v[28:29], v[50:51]
    v_pk_add_f32 v[28:29], v[28:29], v[52:53]
    v_pk_add_f32 v[28:29], v[28:29], v[54:55]
    v_pk_add_f32 v[28:29], v[28:29], v[56:57]
    v_pk_add_f32 v[28:29], v[28:29], v[58:59]
    v_pk_add_f32 v[28:29], v[28:29], v[60:61]
    v_pk_add_f32 v[28:29], v[28:29], v[62:63]
    v_add_f32 v24, v28, v29
    s_nop 1
    v_add_f32_dpp v24, v24, v24 row_ror:8 row_mask:0xf bank_mask:0xf
    v_mov_b32 v25, v24
    s_nop 1
    v_permlane16_swap_b32 v24, v25
    s_nop 1
    v_add_f32 v24, v24, v25
    v_mov_b32 v25, v24
    s_nop 1
    v_permlane32_swap_b32 v24, v25
    s_nop 1
    v_add_f32 v24, v24, v25
    v_lshlrev_b32 v26, 2, v2
    s_lshl_b32 s23, s22, 5
    v_add_u32 v27, s23, v26
    ds_write_b32 v27, v24 offset:0
    s_waitcnt lgkmcnt(0)
    s_barrier
    ds_read_b32 v28, v26 offset:0
    ds_read_b32 v29, v26 offset:32
    ds_read_b32 v30, v26 offset:64
    ds_read_b32 v31, v26 offset:96
    v_lshlrev_b32 v9, 6, v3
    ds_read_b128 v[64:67], v9 offset:1024
    ds_read_b128 v[68:71], v9 offset:1040
    ds_read_b128 v[72:75], v9 offset:1056
    ds_read_b128 v[76:79], v9 offset:1072
    ds_read_b128 v[80:83], v9 offset:1536
    ds_read_b128 v[84:87], v9 offset:1552
    ds_read_b128 v[88:91], v9 offset:1568
    ds_read_b128 v[92:95], v9 offset:1584
    s_waitcnt lgkmcnt(8)
    v_add_f32 v28, v28, v29
    v_add_f32 v30, v30, v31
    v_add_f32 v24, v28, v30
    v_mul_f32 v24, 0x3a800000, v24
    v_sub_f32 v10, 0, v24
    v_mov_b32 v11, v10
    v_mov_b32 v12, 0
    v_mov_b32 v13, 0
    v_pk_add_f32 v[14:15], v[32:33], v[10:11]
    v_pk_fma_f32 v[12:13], v[14:15], v[14:15], v[12:13]
    v_pk_add_f32 v[14:15], v[34:35], v[10:11]
    v_pk_fma_f32 v[12:13], v[14:15], v[14:15], v[12:13]
    v_pk_add_f32 v[14:15], v[36:37], v[10:11]
    v_pk_fma_f32 v[12:13], v[14:15], v[14:15], v[12:13]
    v_pk_add_f32 v[14:15], v[38:39], v[10:11]
    v_pk_fma_f32 v[12:13], v[14:15], v[14:15], v[12:13]
    v_pk_add_f32 v[14:15], v[40:41], v[10:11]
    v_pk_fma_f32 v[12:13], v[14:15], v[14:15], v[12:13]
    v_pk_add_f32 v[14:15], v[42:43], v[10:11]
    v_pk_fma_f32 v[12:13], v[14:15], v[14:15], v[12:13]
    v_pk_add_f32 v[14:15], v[44:45], v[10:11]
    v_pk_fma_f32 v[12:13], v[14:15], v[14:15], v[12:13]
    v_pk_add_f32 v[14:15], v[46:47], v[10:11]
    v_pk_fma_f32 v[12:13], v[14:15], v[14:15], v[12:13]
    v_pk_add_f32 v[14:15], v[48:49], v[10:11]
    v_pk_fma_f32 v[12:13], v[14:15], v[14:15], v[12:13]
    v_pk_add_f32 v[14:15], v[50:51], v[10:11]
    v_pk_fma_f32 v[12:13], v[14:15], v[14:15], v[12:13]
    v_pk_add_f32 v[14:15], v[52:53], v[10:11]
    v_pk_fma_f32 v[12:13], v[14:15], v[14:15], v[12:13]
    v_pk_add_f32 v[14:15], v[54:55], v[10:11]
    v_pk_fma_f32 v[12:13], v[14:15], v[14:15], v[12:13]
    v_pk_add_f32 v[14:15], v[56:57], v[10:11]
    v_pk_fma_f32 v[12:13], v[14:15], v[14:15], v[12:13]
    v_pk_add_f32 v[14:15], v[58:59], v[10:11]
    v_pk_fma_f32 v[12:13], v[14:15], v[14:15], v[12:13]
    v_pk_add_f32 v[14:15], v[60:61], v[10:11]
    v_pk_fma_f32 v[12:13], v[14:15], v[14:15], v[12:13]
    v_pk_add_f32 v[14:15], v[62:63], v[10:11]
    v_pk_fma_f32 v[12:13], v[14:15], v[14:15], v[12:13]
    v_add_f32 v16, v12, v13
    s_nop 1
    v_add_f32_dpp v16, v16, v16 row_ror:8 row_mask:0xf bank_mask:0xf
    v_mov_b32 v25, v16
    s_nop 1
    v_permlane16_swap_b32 v16, v25
    s_nop 1
    v_add_f32 v16, v16, v25
    v_mov_b32 v25, v16
    s_nop 1
    v_permlane32_swap_b32 v16, v25
    s_nop 1
    v_add_f32 v16, v16, v25
    v_lshlrev_b32 v26, 2, v2
    s_lshl_b32 s23, s22, 5
    v_add_u32 v27, s23, v26
    ds_write_b32 v27, v16 offset:256
    s_waitcnt lgkmcnt(0)
    s_barrier
    ds_read_b32 v28, v26 offset:256
    ds_read_b32 v29, v26 offset:288
    ds_read_b32 v30, v26 offset:320
    ds_read_b32 v31, v26 offset:352
    ds_read_b128 v[96:99], v9 offset:5120
    ds_read_b128 v[100:103], v9 offset:5136
    ds_read_b128 v[104:107], v9 offset:5152
    ds_read_b128 v[108:111], v9 offset:5168
    ds_read_b128 v[112:115], v9 offset:5632
    ds_read_b128 v[116:119], v9 offset:5648
    ds_read_b128 v[120:123], v9 offset:5664
    ds_read_b128 v[124:127], v9 offset:5680
    s_waitcnt lgkmcnt(8)
    v_add_f32 v28, v28, v29
    v_add_f32 v30, v30, v31
    v_add_f32 v16, v28, v30
    v_mul_f32 v16, 0x3a800000, v16
    v_cvt_pk_bf16_f32 v25, v16, v24
    v_lshlrev_b32 v16, 16, v25
    v_and_b32 v24, s30, v25
    v_add_f32 v16, 0x3727c5ac, v16
    v_cvt_pk_bf16_f32 v25, v16, v16
    v_lshlrev_b32 v16, 16, v25
    v_sqrt_f32 v16, v16
    v_sub_f32 v10, 0, v24
    v_cvt_pk_bf16_f32 v25, v16, v16
    v_lshlrev_b32 v16, 16, v25
    v_rcp_f32 v16, v16
    v_mov_b32 v11, v10
    s_waitcnt lgkmcnt(0)
    v_mov_b32 v17, v16
    v_pk_add_f32 v[32:33], v[32:33], v[10:11]
    v_cvt_pk_bf16_f32 v25, v32, v33
    v_lshlrev_b32 v32, 16, v25
    v_and_b32 v33, s30, v25
    v_pk_mul_f32 v[32:33], v[32:33], v[16:17]
    v_cvt_pk_bf16_f32 v25, v32, v33
    v_lshlrev_b32 v32, 16, v25
    v_and_b32 v33, s30, v25
    v_pk_mul_f32 v[32:33], v[32:33], v[96:97]
    v_cvt_pk_bf16_f32 v25, v32, v33
    v_lshlrev_b32 v32, 16, v25
    v_and_b32 v33, s30, v25
    v_pk_add_f32 v[32:33], v[32:33], v[64:65]
    v_pk_add_f32 v[34:35], v[34:35], v[10:11]
    v_cvt_pk_bf16_f32 v25, v34, v35
    v_lshlrev_b32 v34, 16, v25
    v_and_b32 v35, s30, v25
    v_pk_mul_f32 v[34:35], v[34:35], v[16:17]
    v_cvt_pk_bf16_f32 v25, v34, v35
    v_lshlrev_b32 v34, 16, v25
    v_and_b32 v35, s30, v25
    v_pk_mul_f32 v[34:35], v[34:35], v[98:99]
    v_cvt_pk_bf16_f32 v25, v34, v35
    v_lshlrev_b32 v34, 16, v25
    v_and_b32 v35, s30, v25
    v_pk_add_f32 v[34:35], v[34:35], v[66:67]
    v_pk_add_f32 v[36:37], v[36:37], v[10:11]
    v_cvt_pk_bf16_f32 v25, v36, v37
    v_lshlrev_b32 v36, 16, v25
    v_and_b32 v37, s30, v25
    v_pk_mul_f32 v[36:37], v[36:37], v[16:17]
    v_cvt_pk_bf16_f32 v25, v36, v37
    v_lshlrev_b32 v36, 16, v25
    v_and_b32 v37, s30, v25
    v_pk_mul_f32 v[36:37], v[36:37], v[100:101]
    v_cvt_pk_bf16_f32 v25, v36, v37
    v_lshlrev_b32 v36, 16, v25
    v_and_b32 v37, s30, v25
    v_pk_add_f32 v[36:37], v[36:37], v[68:69]
    v_pk_add_f32 v[38:39], v[38:39], v[10:11]
    v_cvt_pk_bf16_f32 v25, v38, v39
    v_lshlrev_b32 v38, 16, v25
    v_and_b32 v39, s30, v25
    v_pk_mul_f32 v[38:39], v[38:39], v[16:17]
    v_cvt_pk_bf16_f32 v25, v38, v39
    v_lshlrev_b32 v38, 16, v25
    v_and_b32 v39, s30, v25
    v_pk_mul_f32 v[38:39], v[38:39], v[102:103]
    v_cvt_pk_bf16_f32 v25, v38, v39
    v_lshlrev_b32 v38, 16, v25
    v_and_b32 v39, s30, v25
    v_pk_add_f32 v[38:39], v[38:39], v[70:71]
    v_pk_add_f32 v[40:41], v[40:41], v[10:11]
    v_cvt_pk_bf16_f32 v25, v40, v41
    v_lshlrev_b32 v40, 16, v25
    v_and_b32 v41, s30, v25
    v_pk_mul_f32 v[40:41], v[40:41], v[16:17]
    v_cvt_pk_bf16_f32 v25, v40, v41
    v_lshlrev_b32 v40, 16, v25
    v_and_b32 v41, s30, v25
    v_pk_mul_f32 v[40:41], v[40:41], v[104:105]
    v_cvt_pk_bf16_f32 v25, v40, v41
    v_lshlrev_b32 v40, 16, v25
    v_and_b32 v41, s30, v25
    v_pk_add_f32 v[40:41], v[40:41], v[72:73]
    v_pk_add_f32 v[42:43], v[42:43], v[10:11]
    v_cvt_pk_bf16_f32 v25, v42, v43
    v_lshlrev_b32 v42, 16, v25
    v_and_b32 v43, s30, v25
    v_pk_mul_f32 v[42:43], v[42:43], v[16:17]
    v_cvt_pk_bf16_f32 v25, v42, v43
    v_lshlrev_b32 v42, 16, v25
    v_and_b32 v43, s30, v25
    v_pk_mul_f32 v[42:43], v[42:43], v[106:107]
    v_cvt_pk_bf16_f32 v25, v42, v43
    v_lshlrev_b32 v42, 16, v25
    v_and_b32 v43, s30, v25
    v_pk_add_f32 v[42:43], v[42:43], v[74:75]
    v_pk_add_f32 v[44:45], v[44:45], v[10:11]
    v_cvt_pk_bf16_f32 v25, v44, v45
    v_lshlrev_b32 v44, 16, v25
    v_and_b32 v45, s30, v25
    v_pk_mul_f32 v[44:45], v[44:45], v[16:17]
    v_cvt_pk_bf16_f32 v25, v44, v45
    v_lshlrev_b32 v44, 16, v25
    v_and_b32 v45, s30, v25
    v_pk_mul_f32 v[44:45], v[44:45], v[108:109]
    v_cvt_pk_bf16_f32 v25, v44, v45
    v_lshlrev_b32 v44, 16, v25
    v_and_b32 v45, s30, v25
    v_pk_add_f32 v[44:45], v[44:45], v[76:77]
    v_pk_add_f32 v[46:47], v[46:47], v[10:11]
    v_cvt_pk_bf16_f32 v25, v46, v47
    v_lshlrev_b32 v46, 16, v25
    v_and_b32 v47, s30, v25
    v_pk_mul_f32 v[46:47], v[46:47], v[16:17]
    v_cvt_pk_bf16_f32 v25, v46, v47
    v_lshlrev_b32 v46, 16, v25
    v_and_b32 v47, s30, v25
    v_pk_mul_f32 v[46:47], v[46:47], v[110:111]
    v_cvt_pk_bf16_f32 v25, v46, v47
    v_lshlrev_b32 v46, 16, v25
    v_and_b32 v47, s30, v25
    v_pk_add_f32 v[46:47], v[46:47], v[78:79]
    v_pk_add_f32 v[48:49], v[48:49], v[10:11]
    v_cvt_pk_bf16_f32 v25, v48, v49
    v_lshlrev_b32 v48, 16, v25
    v_and_b32 v49, s30, v25
    v_pk_mul_f32 v[48:49], v[48:49], v[16:17]
    v_cvt_pk_bf16_f32 v25, v48, v49
    v_lshlrev_b32 v48, 16, v25
    v_and_b32 v49, s30, v25
    v_pk_mul_f32 v[48:49], v[48:49], v[112:113]
    v_cvt_pk_bf16_f32 v25, v48, v49
    v_lshlrev_b32 v48, 16, v25
    v_and_b32 v49, s30, v25
    v_pk_add_f32 v[48:49], v[48:49], v[80:81]
    v_pk_add_f32 v[50:51], v[50:51], v[10:11]
    v_cvt_pk_bf16_f32 v25, v50, v51
    v_lshlrev_b32 v50, 16, v25
    v_and_b32 v51, s30, v25
    v_pk_mul_f32 v[50:51], v[50:51], v[16:17]
    v_cvt_pk_bf16_f32 v25, v50, v51
    v_lshlrev_b32 v50, 16, v25
    v_and_b32 v51, s30, v25
    v_pk_mul_f32 v[50:51], v[50:51], v[114:115]
    v_cvt_pk_bf16_f32 v25, v50, v51
    v_lshlrev_b32 v50, 16, v25
    v_and_b32 v51, s30, v25
    v_pk_add_f32 v[50:51], v[50:51], v[82:83]
    v_pk_add_f32 v[52:53], v[52:53], v[10:11]
    v_cvt_pk_bf16_f32 v25, v52, v53
    v_lshlrev_b32 v52, 16, v25
    v_and_b32 v53, s30, v25
    v_pk_mul_f32 v[52:53], v[52:53], v[16:17]
    v_cvt_pk_bf16_f32 v25, v52, v53
    v_lshlrev_b32 v52, 16, v25
    v_and_b32 v53, s30, v25
    v_pk_mul_f32 v[52:53], v[52:53], v[116:117]
    v_cvt_pk_bf16_f32 v25, v52, v53
    v_lshlrev_b32 v52, 16, v25
    v_and_b32 v53, s30, v25
    v_pk_add_f32 v[52:53], v[52:53], v[84:85]
    v_pk_add_f32 v[54:55], v[54:55], v[10:11]
    v_cvt_pk_bf16_f32 v25, v54, v55
    v_lshlrev_b32 v54, 16, v25
    v_and_b32 v55, s30, v25
    v_pk_mul_f32 v[54:55], v[54:55], v[16:17]
    v_cvt_pk_bf16_f32 v25, v54, v55
    v_lshlrev_b32 v54, 16, v25
    v_and_b32 v55, s30, v25
    v_pk_mul_f32 v[54:55], v[54:55], v[118:119]
    v_cvt_pk_bf16_f32 v25, v54, v55
    v_lshlrev_b32 v54, 16, v25
    v_and_b32 v55, s30, v25
    v_pk_add_f32 v[54:55], v[54:55], v[86:87]
    v_pk_add_f32 v[56:57], v[56:57], v[10:11]
    v_cvt_pk_bf16_f32 v25, v56, v57
    v_lshlrev_b32 v56, 16, v25
    v_and_b32 v57, s30, v25
    v_pk_mul_f32 v[56:57], v[56:57], v[16:17]
    v_cvt_pk_bf16_f32 v25, v56, v57
    v_lshlrev_b32 v56, 16, v25
    v_and_b32 v57, s30, v25
    v_pk_mul_f32 v[56:57], v[56:57], v[120:121]
    v_cvt_pk_bf16_f32 v25, v56, v57
    v_lshlrev_b32 v56, 16, v25
    v_and_b32 v57, s30, v25
    v_pk_add_f32 v[56:57], v[56:57], v[88:89]
    v_pk_add_f32 v[58:59], v[58:59], v[10:11]
    v_cvt_pk_bf16_f32 v25, v58, v59
    v_lshlrev_b32 v58, 16, v25
    v_and_b32 v59, s30, v25
    v_pk_mul_f32 v[58:59], v[58:59], v[16:17]
    v_cvt_pk_bf16_f32 v25, v58, v59
    v_lshlrev_b32 v58, 16, v25
    v_and_b32 v59, s30, v25
    v_pk_mul_f32 v[58:59], v[58:59], v[122:123]
    v_cvt_pk_bf16_f32 v25, v58, v59
    v_lshlrev_b32 v58, 16, v25
    v_and_b32 v59, s30, v25
    v_pk_add_f32 v[58:59], v[58:59], v[90:91]
    v_pk_add_f32 v[60:61], v[60:61], v[10:11]
    v_cvt_pk_bf16_f32 v25, v60, v61
    v_lshlrev_b32 v60, 16, v25
    v_and_b32 v61, s30, v25
    v_pk_mul_f32 v[60:61], v[60:61], v[16:17]
    v_cvt_pk_bf16_f32 v25, v60, v61
    v_lshlrev_b32 v60, 16, v25
    v_and_b32 v61, s30, v25
    v_pk_mul_f32 v[60:61], v[60:61], v[124:125]
    v_cvt_pk_bf16_f32 v25, v60, v61
    v_lshlrev_b32 v60, 16, v25
    v_and_b32 v61, s30, v25
    v_pk_add_f32 v[60:61], v[60:61], v[92:93]
    v_pk_add_f32 v[62:63], v[62:63], v[10:11]
    v_cvt_pk_bf16_f32 v25, v62, v63
    v_lshlrev_b32 v62, 16, v25
    v_and_b32 v63, s30, v25
    v_pk_mul_f32 v[62:63], v[62:63], v[16:17]
    v_cvt_pk_bf16_f32 v25, v62, v63
    v_lshlrev_b32 v62, 16, v25
    v_and_b32 v63, s30, v25
    v_pk_mul_f32 v[62:63], v[62:63], v[126:127]
    v_cvt_pk_bf16_f32 v25, v62, v63
    v_lshlrev_b32 v62, 16, v25
    v_and_b32 v63, s30, v25
    v_pk_add_f32 v[62:63], v[62:63], v[94:95]
    v_cvt_pk_bf16_f32 v8, v32, v33
    v_cvt_pk_bf16_f32 v9, v34, v35
    v_cvt_pk_bf16_f32 v10, v40, v41
    v_cvt_pk_bf16_f32 v11, v42, v43
    v_cvt_pk_bf16_f32 v12, v36, v37
    v_cvt_pk_bf16_f32 v13, v38, v39
    v_cvt_pk_bf16_f32 v14, v44, v45
    v_cvt_pk_bf16_f32 v15, v46, v47
    v_cvt_pk_bf16_f32 v16, v48, v49
    v_cvt_pk_bf16_f32 v17, v50, v51
    v_cvt_pk_bf16_f32 v18, v56, v57
    v_cvt_pk_bf16_f32 v19, v58, v59
    v_cvt_pk_bf16_f32 v20, v52, v53
    v_cvt_pk_bf16_f32 v21, v54, v55
    v_cvt_pk_bf16_f32 v22, v60, v61
    v_cvt_pk_bf16_f32 v23, v62, v63
    s_add_u32 s24, s4, 5242880
    s_addc_u32 s25, s5, 0
    s_and_b32 s25, s25, 0xffff
    s_mov_b32 s26, 4194304
    s_mov_b32 s27, 0x20000
    buffer_store_dwordx4 v[8:11], v6, s[24:27], 0 offen sc1
    buffer_store_dwordx4 v[12:15], v6, s[24:27], 0 offen offset:512 sc1
    buffer_store_dwordx4 v[16:19], v6, s[24:27], s35 offen sc1
    buffer_store_dwordx4 v[20:23], v6, s[24:27], s35 offen offset:512 sc1
    s_cmp_ge_u32 s2, 8
    s_cbranch_scc1 NOFIN_6
    v_cmp_gt_u32 vcc, 128, v0
    s_and_saveexec_b64 s[40:41], vcc
    s_cbranch_execz NOFIN_6
    s_waitcnt vmcnt(16)
    v_add_f32 v128, v128, v132
    v_add_f32 v129, v129, v133
    v_add_f32 v130, v130, v134
    v_add_f32 v131, v131, v135
    v_cvt_pk_bf16_f32 v25, v128, v129
    v_lshlrev_b32 v128, 16, v25
    v_and_b32 v129, s30, v25
    v_cvt_pk_bf16_f32 v25, v130, v131
    v_lshlrev_b32 v130, 16, v25
    v_and_b32 v131, s30, v25
    s_lshr_b32 s26, s2, 1
    s_cmp_eq_u32 s26, 2
    s_cselect_b32 s26, 1.0, 0
    v_add_f32 v128, s26, v128
    v_add_f32 v129, s26, v129
    v_add_f32 v130, s26, v130
    v_add_f32 v131, s26, v131
    v_cvt_pk_bf16_f32 v25, v128, v129
    v_lshlrev_b32 v128, 16, v25
    v_and_b32 v129, s30, v25
    v_cvt_pk_bf16_f32 v25, v130, v131
    v_lshlrev_b32 v130, 16, v25
    v_and_b32 v131, s30, v25
    s_mov_b32 s44, s4
    s_and_b32 s45, s5, 0xffff
    s_mov_b32 s46, 24576
    s_mov_b32 s47, 0x20000
    buffer_store_dwordx4 v[128:131], v7, s[44:47], s31 offen sc1
NOFIN_6:
    s_lshr_b32 s20, s2, 4
    s_and_b32 s21, s2, 15
    s_mov_b64 exec, -1
    s_waitcnt vmcnt(0)
    s_barrier
    s_cmp_lg_u32 s22, 0
    s_cbranch_scc1 NOSIG_9
    s_add_u32 s84, s4, 720896
    s_addc_u32 s85, s5, 0
    s_and_b32 s85, s85, 0xffff
    s_mov_b32 s86, 131072
    s_mov_b32 s87, 0x20000
    s_lshl_b32 s88, s20, 7
    s_add_u32 s88, s88, 40960
    s_lshl_b32 s89, s21, 2
    s_add_u32 s88, s88, s89
    s_mov_b64 exec, 1
    v_mov_b32 v254, 1
    v_mov_b32 v255, s88
    buffer_store_dword v254, v255, s[84:87], 0 offen sc1
    s_mov_b64 exec, -1
NOSIG_9:
    s_load_dwordx2 s[4:5], s[0:1], 80
    s_load_dwordx2 s[6:7], s[0:1], 8
    v_lshrrev_b32 v16, 6, v0
    v_and_b32 v1, 63, v0
    v_readfirstlane_b32 s22, v16
    s_and_b32 s16, s2, 7
    s_lshr_b32 s17, s2, 3
    s_lshr_b32 s18, s16, 2
    s_lshl_b32 s18, s18, 3
    s_lshr_b32 s19, s17, 2
    s_add_u32 s20, s18, s19
    s_and_b32 s18, s16, 3
    s_lshl_b32 s18, s18, 2
    s_and_b32 s19, s17, 3
    s_add_u32 s21, s18, s19
    s_lshl_b32 s23, s20, 2
    s_add_u32 s23, s23, s22
    s_mul_i32 s16, s23, 65536
    v_lshlrev_b32 v2, 4, v1
    v_lshrrev_b32 v18, 3, v1
    v_bfe_u32 v19, v1, 4, 1
    v_lshlrev_b32 v19, 2, v19
    v_and_b32 v17, 7, v1
    v_xor_b32 v17, v17, v19
    v_lshlrev_b32 v17, 4, v17
    v_mul_u32_u24 v18, 6144, v18
    v_add_u32 v17, v17, v18
    s_mul_i32 s17, s22, 98304
    v_add_u32 v17, s17, v17
    s_mul_i32 s26, s22, 2048
    s_add_u32 s38, s21, 0
    s_and_b32 s38, s38, 15
    s_lshl_b32 s18, s38, 7
    v_add_u32 v18, s18, v17
    v_mov_b32 v8, v18
    v_add_u32 v9, 49152, v18
    s_add_u32 s39, s21, 4
    s_and_b32 s39, s39, 15
    s_lshl_b32 s18, s39, 7
    v_add_u32 v18, s18, v17
    v_add_u32 v10, 2048, v18
    v_add_u32 v11, 51200, v18
    s_add_u32 s40, s21, 8
    s_and_b32 s40, s40, 15
    s_lshl_b32 s18, s40, 7
    v_add_u32 v18, s18, v17
    v_add_u32 v12, 4096, v18
    v_add_u32 v13, 53248, v18
    s_waitcnt lgkmcnt(0)
    s_add_u32 s8, s4, s16
    s_addc_u32 s9, s5, 0
    s_add_u32 s8, s8, 5242880
    s_addc_u32 s9, s9, 0
    s_and_b32 s9, s9, 0xffff
    s_mov_b32 s10, 65536
    s_mov_b32 s11, 0x20000
    s_mov_b32 s12, s6
    s_and_b32 s13, s7, 0xffff
    s_mov_b32 s14, 6291456
    s_mov_b32 s15, 0x20000
    s_mov_b32 s24, 0
    s_mov_b32 s25, 0
    s_add_u32 m0, s26, 0
    s_nop 0
    buffer_load_dwordx4 v8, s[12:15], s25 offen lds
    s_add_u32 m0, s26, 1024
    s_nop 0
    buffer_load_dwordx4 v9, s[12:15], s25 offen lds
    s_add_u32 m0, s26, 8192
    s_nop 0
    buffer_load_dwordx4 v10, s[12:15], s25 offen lds
    s_add_u32 m0, s26, 9216
    s_nop 0
    buffer_load_dwordx4 v11, s[12:15], s25 offen lds
    s_add_u32 m0, s26, 16384
    s_nop 0
    buffer_load_dwordx4 v12, s[12:15], s25 offen lds
    s_add_u32 m0, s26, 17408
    s_nop 0
    buffer_load_dwordx4 v13, s[12:15], s25 offen lds
    s_add_u32 s25, s25, 393216
    s_add_u32 m0, s26, 24576
    s_nop 0
    buffer_load_dwordx4 v8, s[12:15], s25 offen lds
    s_add_u32 m0, s26, 25600
    s_nop 0
    buffer_load_dwordx4 v9, s[12:15], s25 offen lds
    s_add_u32 m0, s26, 32768
    s_nop 0
    buffer_load_dwordx4 v10, s[12:15], s25 offen lds
    s_add_u32 m0, s26, 33792
    s_nop 0
    buffer_load_dwordx4 v11, s[12:15], s25 offen lds
    s_add_u32 m0, s26, 40960
    s_nop 0
    buffer_load_dwordx4 v12, s[12:15], s25 offen lds
    s_add_u32 m0, s26, 41984
    s_nop 0
    buffer_load_dwordx4 v13, s[12:15], s25 offen lds
    s_add_u32 s25, s25, 393216
    s_cmp_lg_u32 s22, 0
    s_cbranch_scc1 NOWAIT_13
    s_add_u32 s84, s4, 720896
    s_addc_u32 s85, s5, 0
    s_and_b32 s85, s85, 0xffff
    s_mov_b32 s86, 131072
    s_mov_b32 s87, 0x20000
    v_and_b32 v254, 63, v0
    v_lshlrev_b32 v254, 2, v254
    s_lshl_b32 s88, s20, 7
    s_add_u32 s88, s88, 40960
    s_mov_b32 exec_lo, 0xffff
    s_mov_b32 exec_hi, 0x0
    s_mov_b32 s89, 0x8000
WLP_14:
    buffer_load_dword v255, v254, s[84:87], s88 offen sc1
    s_waitcnt vmcnt(0)
    v_cmp_ne_u32 vcc, 1, v255
    s_sub_u32 s89, s89, 1
    s_cmp_eq_u32 s89, 0
    s_cbranch_scc1 WDN_15
    s_nop 1
    s_cmp_eq_u64 vcc, 0
    s_cbranch_scc0 WLP_14
WDN_15:
    s_mov_b64 exec, -1
NOWAIT_13:
    s_barrier
    buffer_load_dwordx4 a[0:3], v2, s[8:11], s24 offen offset:0 sc1
    buffer_load_dwordx4 a[4:7], v2, s[8:11], s24 offen offset:1024 sc1
    buffer_load_dwordx4 a[8:11], v2, s[8:11], s24 offen offset:2048 sc1
    buffer_load_dwordx4 a[12:15], v2, s[8:11], s24 offen offset:3072 sc1
    s_add_u32 s24, s24, 4096
    buffer_load_dwordx4 a[16:19], v2, s[8:11], s24 offen offset:0 sc1
    buffer_load_dwordx4 a[20:23], v2, s[8:11], s24 offen offset:1024 sc1
    buffer_load_dwordx4 a[24:27], v2, s[8:11], s24 offen offset:2048 sc1
    buffer_load_dwordx4 a[28:31], v2, s[8:11], s24 offen offset:3072 sc1
    s_add_u32 s24, s24, 4096
    s_add_u32 m0, s26, 49152
    s_nop 0
    buffer_load_dwordx4 v8, s[12:15], s25 offen lds
    s_add_u32 m0, s26, 50176
    s_nop 0
    buffer_load_dwordx4 v9, s[12:15], s25 offen lds
    s_add_u32 m0, s26, 57344
    s_nop 0
    buffer_load_dwordx4 v10, s[12:15], s25 offen lds
    v_lshrrev_b32 v18, 5, v1
    v_lshlrev_b32 v18, 2, v18
    v_bfe_u32 v19, v1, 2, 2
    v_add_u32 v18, v18, v19
    v_lshlrev_b32 v18, 7, v18
    v_bfe_u32 v19, v1, 4, 1
    v_lshlrev_b32 v19, 1, v19
    v_bfe_u32 v20, v1, 1, 1
    v_add_u32 v19, v19, v20
    v_bfe_u32 v20, v1, 3, 1
    v_lshlrev_b32 v20, 2, v20
    v_xor_b32 v19, v19, v20
    v_lshlrev_b32 v19, 4, v19
    v_add_u32 v18, v18, v19
    v_and_b32 v20, 1, v1
    v_lshlrev_b32 v20, 3, v20
    v_add_u32 v3, v18, v20
    v_xor_b32 v4, 64, v3
    v_mov_b32 v32, 0
    v_mov_b32 v33, 0
    v_mov_b32 v34, 0
    v_mov_b32 v35, 0
    v_mov_b32 v36, 0
    v_mov_b32 v37, 0
    v_mov_b32 v38, 0
    v_mov_b32 v39, 0
    v_mov_b32 v40, 0
    v_mov_b32 v41, 0
    v_mov_b32 v42, 0
    v_mov_b32 v43, 0
    v_mov_b32 v44, 0
    v_mov_b32 v45, 0
    v_mov_b32 v46, 0
    v_mov_b32 v47, 0
    v_mov_b32 v48, 0
    v_mov_b32 v49, 0
    v_mov_b32 v50, 0
    v_mov_b32 v51, 0
    v_mov_b32 v52, 0
    v_mov_b32 v53, 0
    v_mov_b32 v54, 0
    v_mov_b32 v55, 0
    v_mov_b32 v56, 0
    v_mov_b32 v57, 0
    v_mov_b32 v58, 0
    v_mov_b32 v59, 0
    v_mov_b32 v60, 0
    v_mov_b32 v61, 0
    v_mov_b32 v62, 0
    v_mov_b32 v63, 0
    v_mov_b32 v64, 0
    v_mov_b32 v65, 0
    v_mov_b32 v66, 0
    v_mov_b32 v67, 0
    v_mov_b32 v68, 0
    v_mov_b32 v69, 0
    v_mov_b32 v70, 0
    v_mov_b32 v71, 0
    v_mov_b32 v72, 0
    v_mov_b32 v73, 0
    v_mov_b32 v74, 0
    v_mov_b32 v75, 0
    v_mov_b32 v76, 0
    v_mov_b32 v77, 0
    v_mov_b32 v78, 0
    v_mov_b32 v79, 0
    v_mov_b32 v80, 0
    v_mov_b32 v81, 0
    v_mov_b32 v82, 0
    v_mov_b32 v83, 0
    v_mov_b32 v84, 0
    v_mov_b32 v85, 0
    v_mov_b32 v86, 0
    v_mov_b32 v87, 0
    v_mov_b32 v88, 0
    v_mov_b32 v89, 0
    v_mov_b32 v90, 0
    v_mov_b32 v91, 0
    v_mov_b32 v92, 0
    v_mov_b32 v93, 0
    v_mov_b32 v94, 0
    v_mov_b32 v95, 0
    v_mov_b32 v96, 0
    v_mov_b32 v97, 0
    v_mov_b32 v98, 0
    v_mov_b32 v99, 0
    v_mov_b32 v100, 0
    v_mov_b32 v101, 0
    v_mov_b32 v102, 0
    v_mov_b32 v103, 0
    v_mov_b32 v104, 0
    v_mov_b32 v105, 0
    v_mov_b32 v106, 0
    v_mov_b32 v107, 0
    v_mov_b32 v108, 0
    v_mov_b32 v109, 0
    v_mov_b32 v110, 0
    v_mov_b32 v111, 0
    v_mov_b32 v112, 0
    v_mov_b32 v113, 0
    v_mov_b32 v114, 0
    v_mov_b32 v115, 0
    v_mov_b32 v116, 0
    v_mov_b32 v117, 0
    v_mov_b32 v118, 0
    v_mov_b32 v119, 0
    v_mov_b32 v120, 0
    v_mov_b32 v121, 0
    v_mov_b32 v122, 0
    v_mov_b32 v123, 0
    v_mov_b32 v124, 0
    v_mov_b32 v125, 0
    v_mov_b32 v126, 0
    v_mov_b32 v127, 0
    s_mov_b32 s30, 0xffff0000
    v_add_u32 v5, 0, v3
    v_add_u32 v6, 0, v4
    s_mov_b32 s27, 4
    s_waitcnt vmcnt(7)
    s_barrier
    ds_read_b64_tr_b16 v[128:129], v5 offset:0
    ds_read_b64_tr_b16 v[130:131], v5 offset:1024
    ds_read_b64_tr_b16 v[132:133], v6 offset:0
    ds_read_b64_tr_b16 v[134:135], v6 offset:1024
    ds_read_b64_tr_b16 v[136:137], v5 offset:8192
    ds_read_b64_tr_b16 v[138:139], v5 offset:9216
    ds_read_b64_tr_b16 v[140:141], v6 offset:8192
    ds_read_b64_tr_b16 v[142:143], v6 offset:9216
    ds_read_b64_tr_b16 v[144:145], v5 offset:16384
    ds_read_b64_tr_b16 v[146:147], v5 offset:17408
    ds_read_b64_tr_b16 v[148:149], v6 offset:16384
    ds_read_b64_tr_b16 v[150:151], v6 offset:17408
LOOP_11:
    s_waitcnt lgkmcnt(0)
    v_mfma_f32_32x32x16_bf16 v[32:47], v[128:131], a[0:3], v[32:47]
    s_add_u32 m0, s26, 58368
    ds_read_b64_tr_b16 v[152:153], v5 offset:2048
    buffer_load_dwordx4 v11, s[12:15], s25 offen lds
    ds_read_b64_tr_b16 v[154:155], v5 offset:3072
    ds_read_b64_tr_b16 v[156:157], v6 offset:2048
    v_mfma_f32_32x32x16_bf16 v[48:63], v[132:135], a[0:3], v[48:63]
    ds_read_b64_tr_b16 v[158:159], v6 offset:3072
    ds_read_b64_tr_b16 v[160:161], v5 offset:10240
    ds_read_b64_tr_b16 v[162:163], v5 offset:11264
    v_mfma_f32_32x32x16_bf16 v[64:79], v[136:139], a[0:3], v[64:79]
    s_add_u32 m0, s26, 65536
    ds_read_b64_tr_b16 v[164:165], v6 offset:10240
    buffer_load_dwordx4 v12, s[12:15], s25 offen lds
    ds_read_b64_tr_b16 v[166:167], v6 offset:11264
    ds_read_b64_tr_b16 v[168:169], v5 offset:18432
    v_mfma_f32_32x32x16_bf16 v[80:95], v[140:143], a[0:3], v[80:95]
    s_add_u32 m0, s26, 66560
    ds_read_b64_tr_b16 v[170:171], v5 offset:19456
    buffer_load_dwordx4 v13, s[12:15], s25 offen lds
    ds_read_b64_tr_b16 v[172:173], v6 offset:18432
    ds_read_b64_tr_b16 v[174:175], v6 offset:19456
    v_mfma_f32_32x32x16_bf16 v[96:111], a[0:3], v[144:147], v[96:111]
    v_mfma_f32_32x32x16_bf16 v[112:127], a[0:3], v[148:151], v[112:127]
    buffer_load_dwordx4 a[32:35], v2, s[8:11], s24 offen offset:0 sc1
    s_waitcnt lgkmcnt(0)
    v_mfma_f32_32x32x16_bf16 v[32:47], v[152:155], a[4:7], v[32:47]
    ds_read_b64_tr_b16 v[128:129], v5 offset:4096
    ds_read_b64_tr_b16 v[130:131], v5 offset:5120
    ds_read_b64_tr_b16 v[132:133], v6 offset:4096
    v_mfma_f32_32x32x16_bf16 v[48:63], v[156:159], a[4:7], v[48:63]
    ds_read_b64_tr_b16 v[134:135], v6 offset:5120
    ds_read_b64_tr_b16 v[136:137], v5 offset:12288
    ds_read_b64_tr_b16 v[138:139], v5 offset:13312
    buffer_load_dwordx4 a[36:39], v2, s[8:11], s24 offen offset:1024 sc1
    v_mfma_f32_32x32x16_bf16 v[64:79], v[160:163], a[4:7], v[64:79]
    ds_read_b64_tr_b16 v[140:141], v6 offset:12288
    ds_read_b64_tr_b16 v[142:143], v6 offset:13312
    ds_read_b64_tr_b16 v[144:145], v5 offset:20480
    v_mfma_f32_32x32x16_bf16 v[80:95], v[164:167], a[4:7], v[80:95]
    ds_read_b64_tr_b16 v[146:147], v5 offset:21504
    ds_read_b64_tr_b16 v[148:149], v6 offset:20480
    ds_read_b64_tr_b16 v[150:151], v6 offset:21504
    buffer_load_dwordx4 a[40:43], v2, s[8:11], s24 offen offset:2048 sc1
    v_mfma_f32_32x32x16_bf16 v[96:111], a[4:7], v[168:171], v[96:111]
    v_mfma_f32_32x32x16_bf16 v[112:127], a[4:7], v[172:175], v[112:127]
    buffer_load_dwordx4 a[44:47], v2, s[8:11], s24 offen offset:3072 sc1
    s_waitcnt lgkmcnt(0)
    v_mfma_f32_32x32x16_bf16 v[32:47], v[128:131], a[8:11], v[32:47]
    ds_read_b64_tr_b16 v[152:153], v5 offset:6144
    ds_read_b64_tr_b16 v[154:155], v5 offset:7168
    ds_read_b64_tr_b16 v[156:157], v6 offset:6144
    v_mfma_f32_32x32x16_bf16 v[48:63], v[132:135], a[8:11], v[48:63]
    ds_read_b64_tr_b16 v[158:159], v6 offset:7168
    ds_read_b64_tr_b16 v[160:161], v5 offset:14336
    ds_read_b64_tr_b16 v[162:163], v5 offset:15360
    v_mfma_f32_32x32x16_bf16 v[64:79], v[136:139], a[8:11], v[64:79]
    ds_read_b64_tr_b16 v[164:165], v6 offset:14336
    ds_read_b64_tr_b16 v[166:167], v6 offset:15360
    ds_read_b64_tr_b16 v[168:169], v5 offset:22528
    v_mfma_f32_32x32x16_bf16 v[80:95], v[140:143], a[8:11], v[80:95]
    ds_read_b64_tr_b16 v[170:171], v5 offset:23552
    ds_read_b64_tr_b16 v[172:173], v6 offset:22528
    ds_read_b64_tr_b16 v[174:175], v6 offset:23552
    v_mfma_f32_32x32x16_bf16 v[96:111], a[8:11], v[144:147], v[96:111]
    v_mfma_f32_32x32x16_bf16 v[112:127], a[8:11], v[148:151], v[112:127]
    s_add_u32 s24, s24, 4096
    s_add_u32 s25, s25, 393216
    s_waitcnt lgkmcnt(0)
    s_waitcnt vmcnt(10)
    s_barrier
    v_add_u32 v5, 24576, v3
    v_add_u32 v6, 24576, v4
    v_mfma_f32_32x32x16_bf16 v[32:47], v[152:155], a[12:15], v[32:47]
    ds_read_b64_tr_b16 v[128:129], v5 offset:0
    ds_read_b64_tr_b16 v[130:131], v5 offset:1024
    ds_read_b64_tr_b16 v[132:133], v6 offset:0
    v_mfma_f32_32x32x16_bf16 v[48:63], v[156:159], a[12:15], v[48:63]
    s_add_u32 m0, s26, 73728
    ds_read_b64_tr_b16 v[134:135], v6 offset:1024
    buffer_load_dwordx4 v8, s[12:15], s25 offen lds
    ds_read_b64_tr_b16 v[136:137], v5 offset:8192
    ds_read_b64_tr_b16 v[138:139], v5 offset:9216
    v_mfma_f32_32x32x16_bf16 v[64:79], v[160:163], a[12:15], v[64:79]
    ds_read_b64_tr_b16 v[140:141], v6 offset:8192
    ds_read_b64_tr_b16 v[142:143], v6 offset:9216
    ds_read_b64_tr_b16 v[144:145], v5 offset:16384
    v_mfma_f32_32x32x16_bf16 v[80:95], v[164:167], a[12:15], v[80:95]
    s_add_u32 m0, s26, 74752
    ds_read_b64_tr_b16 v[146:147], v5 offset:17408
    buffer_load_dwordx4 v9, s[12:15], s25 offen lds
    ds_read_b64_tr_b16 v[148:149], v6 offset:16384
    ds_read_b64_tr_b16 v[150:151], v6 offset:17408
    v_mfma_f32_32x32x16_bf16 v[96:111], a[12:15], v[168:171], v[96:111]
    v_mfma_f32_32x32x16_bf16 v[112:127], a[12:15], v[172:175], v[112:127]
    s_add_u32 m0, s26, 81920
    s_nop 0
    buffer_load_dwordx4 v10, s[12:15], s25 offen lds
    s_waitcnt lgkmcnt(0)
    v_mfma_f32_32x32x16_bf16 v[32:47], v[128:131], a[16:19], v[32:47]
    s_add_u32 m0, s26, 82944
    ds_read_b64_tr_b16 v[152:153], v5 offset:2048
    buffer_load_dwordx4 v11, s[12:15], s25 offen lds
    ds_read_b64_tr_b16 v[154:155], v5 offset:3072
    ds_read_b64_tr_b16 v[156:157], v6 offset:2048
    v_mfma_f32_32x32x16_bf16 v[48:63], v[132:135], a[16:19], v[48:63]
    ds_read_b64_tr_b16 v[158:159], v6 offset:3072
    ds_read_b64_tr_b16 v[160:161], v5 offset:10240
    ds_read_b64_tr_b16 v[162:163], v5 offset:11264
    v_mfma_f32_32x32x16_bf16 v[64:79], v[136:139], a[16:19], v[64:79]
    s_add_u32 m0, s26, 90112
    ds_read_b64_tr_b16 v[164:165], v6 offset:10240
    buffer_load_dwordx4 v12, s[12:15], s25 offen lds
    ds_read_b64_tr_b16 v[166:167], v6 offset:11264
    ds_read_b64_tr_b16 v[168:169], v5 offset:18432
    v_mfma_f32_32x32x16_bf16 v[80:95], v[140:143], a[16:19], v[80:95]
    s_add_u32 m0, s26, 91136
    ds_read_b64_tr_b16 v[170:171], v5 offset:19456
    buffer_load_dwordx4 v13, s[12:15], s25 offen lds
    ds_read_b64_tr_b16 v[172:173], v6 offset:18432
    ds_read_b64_tr_b16 v[174:175], v6 offset:19456
    v_mfma_f32_32x32x16_bf16 v[96:111], a[16:19], v[144:147], v[96:111]
    v_mfma_f32_32x32x16_bf16 v[112:127], a[16:19], v[148:151], v[112:127]
    buffer_load_dwordx4 a[48:51], v2, s[8:11], s24 offen offset:0 sc1
    s_waitcnt lgkmcnt(0)
    v_mfma_f32_32x32x16_bf16 v[32:47], v[152:155], a[20:23], v[32:47]
    ds_read_b64_tr_b16 v[128:129], v5 offset:4096
    ds_read_b64_tr_b16 v[130:131], v5 offset:5120
    ds_read_b64_tr_b16 v[132:133], v6 offset:4096
    v_mfma_f32_32x32x16_bf16 v[48:63], v[156:159], a[20:23], v[48:63]
    ds_read_b64_tr_b16 v[134:135], v6 offset:5120
    ds_read_b64_tr_b16 v[136:137], v5 offset:12288
    ds_read_b64_tr_b16 v[138:139], v5 offset:13312
    buffer_load_dwordx4 a[52:55], v2, s[8:11], s24 offen offset:1024 sc1
    v_mfma_f32_32x32x16_bf16 v[64:79], v[160:163], a[20:23], v[64:79]
    ds_read_b64_tr_b16 v[140:141], v6 offset:12288
    ds_read_b64_tr_b16 v[142:143], v6 offset:13312
    ds_read_b64_tr_b16 v[144:145], v5 offset:20480
    v_mfma_f32_32x32x16_bf16 v[80:95], v[164:167], a[20:23], v[80:95]
    ds_read_b64_tr_b16 v[146:147], v5 offset:21504
    ds_read_b64_tr_b16 v[148:149], v6 offset:20480
    ds_read_b64_tr_b16 v[150:151], v6 offset:21504
    buffer_load_dwordx4 a[56:59], v2, s[8:11], s24 offen offset:2048 sc1
    v_mfma_f32_32x32x16_bf16 v[96:111], a[20:23], v[168:171], v[96:111]
    v_mfma_f32_32x32x16_bf16 v[112:127], a[20:23], v[172:175], v[112:127]
    buffer_load_dwordx4 a[60:63], v2, s[8:11], s24 offen offset:3072 sc1
    s_waitcnt lgkmcnt(0)
    v_mfma_f32_32x32x16_bf16 v[32:47], v[128:131], a[24:27], v[32:47]
    ds_read_b64_tr_b16 v[152:153], v5 offset:6144
    ds_read_b64_tr_b16 v[154:155], v5 offset:7168
    ds_read_b64_tr_b16 v[156:157], v6 offset:6144
    v_mfma_f32_32x32x16_bf16 v[48:63], v[132:135], a[24:27], v[48:63]
    ds_read_b64_tr_b16 v[158:159], v6 offset:7168
    ds_read_b64_tr_b16 v[160:161], v5 offset:14336
    ds_read_b64_tr_b16 v[162:163], v5 offset:15360
    v_mfma_f32_32x32x16_bf16 v[64:79], v[136:139], a[24:27], v[64:79]
    ds_read_b64_tr_b16 v[164:165], v6 offset:14336
    ds_read_b64_tr_b16 v[166:167], v6 offset:15360
    ds_read_b64_tr_b16 v[168:169], v5 offset:22528
    v_mfma_f32_32x32x16_bf16 v[80:95], v[140:143], a[24:27], v[80:95]
    ds_read_b64_tr_b16 v[170:171], v5 offset:23552
    ds_read_b64_tr_b16 v[172:173], v6 offset:22528
    ds_read_b64_tr_b16 v[174:175], v6 offset:23552
    v_mfma_f32_32x32x16_bf16 v[96:111], a[24:27], v[144:147], v[96:111]
    v_mfma_f32_32x32x16_bf16 v[112:127], a[24:27], v[148:151], v[112:127]
    s_add_u32 s24, s24, 4096
    s_add_u32 s25, s25, 393216
    s_waitcnt lgkmcnt(0)
    s_waitcnt vmcnt(10)
    s_barrier
    v_add_u32 v5, 49152, v3
    v_add_u32 v6, 49152, v4
    v_mfma_f32_32x32x16_bf16 v[32:47], v[152:155], a[28:31], v[32:47]
    ds_read_b64_tr_b16 v[128:129], v5 offset:0
    ds_read_b64_tr_b16 v[130:131], v5 offset:1024
    ds_read_b64_tr_b16 v[132:133], v6 offset:0
    v_mfma_f32_32x32x16_bf16 v[48:63], v[156:159], a[28:31], v[48:63]
    s_add_u32 m0, s26, 0
    ds_read_b64_tr_b16 v[134:135], v6 offset:1024
    buffer_load_dwordx4 v8, s[12:15], s25 offen lds
    ds_read_b64_tr_b16 v[136:137], v5 offset:8192
    ds_read_b64_tr_b16 v[138:139], v5 offset:9216
    v_mfma_f32_32x32x16_bf16 v[64:79], v[160:163], a[28:31], v[64:79]
    ds_read_b64_tr_b16 v[140:141], v6 offset:8192
    ds_read_b64_tr_b16 v[142:143], v6 offset:9216
    ds_read_b64_tr_b16 v[144:145], v5 offset:16384
    v_mfma_f32_32x32x16_bf16 v[80:95], v[164:167], a[28:31], v[80:95]
    s_add_u32 m0, s26, 1024
    ds_read_b64_tr_b16 v[146:147], v5 offset:17408
    buffer_load_dwordx4 v9, s[12:15], s25 offen lds
    ds_read_b64_tr_b16 v[148:149], v6 offset:16384
    ds_read_b64_tr_b16 v[150:151], v6 offset:17408
    v_mfma_f32_32x32x16_bf16 v[96:111], a[28:31], v[168:171], v[96:111]
    v_mfma_f32_32x32x16_bf16 v[112:127], a[28:31], v[172:175], v[112:127]
    s_add_u32 m0, s26, 8192
    s_nop 0
    buffer_load_dwordx4 v10, s[12:15], s25 offen lds
    s_waitcnt lgkmcnt(0)
    v_mfma_f32_32x32x16_bf16 v[32:47], v[128:131], a[32:35], v[32:47]
    s_add_u32 m0, s26, 9216
    ds_read_b64_tr_b16 v[152:153], v5 offset:2048
    buffer_load_dwordx4 v11, s[12:15], s25 offen lds
    ds_read_b64_tr_b16 v[154:155], v5 offset:3072
    ds_read_b64_tr_b16 v[156:157], v6 offset:2048
    v_mfma_f32_32x32x16_bf16 v[48:63], v[132:135], a[32:35], v[48:63]
    ds_read_b64_tr_b16 v[158:159], v6 offset:3072
    ds_read_b64_tr_b16 v[160:161], v5 offset:10240
    ds_read_b64_tr_b16 v[162:163], v5 offset:11264
    v_mfma_f32_32x32x16_bf16 v[64:79], v[136:139], a[32:35], v[64:79]
    s_add_u32 m0, s26, 16384
    ds_read_b64_tr_b16 v[164:165], v6 offset:10240
    buffer_load_dwordx4 v12, s[12:15], s25 offen lds
    ds_read_b64_tr_b16 v[166:167], v6 offset:11264
    ds_read_b64_tr_b16 v[168:169], v5 offset:18432
    v_mfma_f32_32x32x16_bf16 v[80:95], v[140:143], a[32:35], v[80:95]
    s_add_u32 m0, s26, 17408
    ds_read_b64_tr_b16 v[170:171], v5 offset:19456
    buffer_load_dwordx4 v13, s[12:15], s25 offen lds
    ds_read_b64_tr_b16 v[172:173], v6 offset:18432
    ds_read_b64_tr_b16 v[174:175], v6 offset:19456
    v_mfma_f32_32x32x16_bf16 v[96:111], a[32:35], v[144:147], v[96:111]
    v_mfma_f32_32x32x16_bf16 v[112:127], a[32:35], v[148:151], v[112:127]
    buffer_load_dwordx4 a[0:3], v2, s[8:11], s24 offen offset:0 sc1
    s_waitcnt lgkmcnt(0)
    v_mfma_f32_32x32x16_bf16 v[32:47], v[152:155], a[36:39], v[32:47]
    ds_read_b64_tr_b16 v[128:129], v5 offset:4096
    ds_read_b64_tr_b16 v[130:131], v5 offset:5120
    ds_read_b64_tr_b16 v[132:133], v6 offset:4096
    v_mfma_f32_32x32x16_bf16 v[48:63], v[156:159], a[36:39], v[48:63]
    ds_read_b64_tr_b16 v[134:135], v6 offset:5120
    ds_read_b64_tr_b16 v[136:137], v5 offset:12288
    ds_read_b64_tr_b16 v[138:139], v5 offset:13312
    buffer_load_dwordx4 a[4:7], v2, s[8:11], s24 offen offset:1024 sc1
    v_mfma_f32_32x32x16_bf16 v[64:79], v[160:163], a[36:39], v[64:79]
    ds_read_b64_tr_b16 v[140:141], v6 offset:12288
    ds_read_b64_tr_b16 v[142:143], v6 offset:13312
    ds_read_b64_tr_b16 v[144:145], v5 offset:20480
    v_mfma_f32_32x32x16_bf16 v[80:95], v[164:167], a[36:39], v[80:95]
    ds_read_b64_tr_b16 v[146:147], v5 offset:21504
    ds_read_b64_tr_b16 v[148:149], v6 offset:20480
    ds_read_b64_tr_b16 v[150:151], v6 offset:21504
    buffer_load_dwordx4 a[8:11], v2, s[8:11], s24 offen offset:2048 sc1
    v_mfma_f32_32x32x16_bf16 v[96:111], a[36:39], v[168:171], v[96:111]
    v_mfma_f32_32x32x16_bf16 v[112:127], a[36:39], v[172:175], v[112:127]
    buffer_load_dwordx4 a[12:15], v2, s[8:11], s24 offen offset:3072 sc1
    s_waitcnt lgkmcnt(0)
    v_mfma_f32_32x32x16_bf16 v[32:47], v[128:131], a[40:43], v[32:47]
    ds_read_b64_tr_b16 v[152:153], v5 offset:6144
    ds_read_b64_tr_b16 v[154:155], v5 offset:7168
    ds_read_b64_tr_b16 v[156:157], v6 offset:6144
    v_mfma_f32_32x32x16_bf16 v[48:63], v[132:135], a[40:43], v[48:63]
    ds_read_b64_tr_b16 v[158:159], v6 offset:7168
    ds_read_b64_tr_b16 v[160:161], v5 offset:14336
    ds_read_b64_tr_b16 v[162:163], v5 offset:15360
    v_mfma_f32_32x32x16_bf16 v[64:79], v[136:139], a[40:43], v[64:79]
    ds_read_b64_tr_b16 v[164:165], v6 offset:14336
    ds_read_b64_tr_b16 v[166:167], v6 offset:15360
    ds_read_b64_tr_b16 v[168:169], v5 offset:22528
    v_mfma_f32_32x32x16_bf16 v[80:95], v[140:143], a[40:43], v[80:95]
    ds_read_b64_tr_b16 v[170:171], v5 offset:23552
    ds_read_b64_tr_b16 v[172:173], v6 offset:22528
    ds_read_b64_tr_b16 v[174:175], v6 offset:23552
    v_mfma_f32_32x32x16_bf16 v[96:111], a[40:43], v[144:147], v[96:111]
    v_mfma_f32_32x32x16_bf16 v[112:127], a[40:43], v[148:151], v[112:127]
    s_add_u32 s24, s24, 4096
    s_add_u32 s25, s25, 393216
    s_waitcnt lgkmcnt(0)
    s_waitcnt vmcnt(10)
    s_barrier
    v_add_u32 v5, 73728, v3
    v_add_u32 v6, 73728, v4
    v_mfma_f32_32x32x16_bf16 v[32:47], v[152:155], a[44:47], v[32:47]
    ds_read_b64_tr_b16 v[128:129], v5 offset:0
    ds_read_b64_tr_b16 v[130:131], v5 offset:1024
    ds_read_b64_tr_b16 v[132:133], v6 offset:0
    v_mfma_f32_32x32x16_bf16 v[48:63], v[156:159], a[44:47], v[48:63]
    s_add_u32 m0, s26, 24576
    ds_read_b64_tr_b16 v[134:135], v6 offset:1024
    buffer_load_dwordx4 v8, s[12:15], s25 offen lds
    ds_read_b64_tr_b16 v[136:137], v5 offset:8192
    ds_read_b64_tr_b16 v[138:139], v5 offset:9216
    v_mfma_f32_32x32x16_bf16 v[64:79], v[160:163], a[44:47], v[64:79]
    ds_read_b64_tr_b16 v[140:141], v6 offset:8192
    ds_read_b64_tr_b16 v[142:143], v6 offset:9216
    ds_read_b64_tr_b16 v[144:145], v5 offset:16384
    v_mfma_f32_32x32x16_bf16 v[80:95], v[164:167], a[44:47], v[80:95]
    s_add_u32 m0, s26, 25600
    ds_read_b64_tr_b16 v[146:147], v5 offset:17408
    buffer_load_dwordx4 v9, s[12:15], s25 offen lds
    ds_read_b64_tr_b16 v[148:149], v6 offset:16384
    ds_read_b64_tr_b16 v[150:151], v6 offset:17408
    v_mfma_f32_32x32x16_bf16 v[96:111], a[44:47], v[168:171], v[96:111]
    v_mfma_f32_32x32x16_bf16 v[112:127], a[44:47], v[172:175], v[112:127]
    s_add_u32 m0, s26, 32768
    s_nop 0
    buffer_load_dwordx4 v10, s[12:15], s25 offen lds
    s_waitcnt lgkmcnt(0)
    v_mfma_f32_32x32x16_bf16 v[32:47], v[128:131], a[48:51], v[32:47]
    s_add_u32 m0, s26, 33792
    ds_read_b64_tr_b16 v[152:153], v5 offset:2048
    buffer_load_dwordx4 v11, s[12:15], s25 offen lds
    ds_read_b64_tr_b16 v[154:155], v5 offset:3072
    ds_read_b64_tr_b16 v[156:157], v6 offset:2048
    v_mfma_f32_32x32x16_bf16 v[48:63], v[132:135], a[48:51], v[48:63]
    ds_read_b64_tr_b16 v[158:159], v6 offset:3072
    ds_read_b64_tr_b16 v[160:161], v5 offset:10240
    ds_read_b64_tr_b16 v[162:163], v5 offset:11264
    v_mfma_f32_32x32x16_bf16 v[64:79], v[136:139], a[48:51], v[64:79]
    s_add_u32 m0, s26, 40960
    ds_read_b64_tr_b16 v[164:165], v6 offset:10240
    buffer_load_dwordx4 v12, s[12:15], s25 offen lds
    ds_read_b64_tr_b16 v[166:167], v6 offset:11264
    ds_read_b64_tr_b16 v[168:169], v5 offset:18432
    v_mfma_f32_32x32x16_bf16 v[80:95], v[140:143], a[48:51], v[80:95]
    s_add_u32 m0, s26, 41984
    ds_read_b64_tr_b16 v[170:171], v5 offset:19456
    buffer_load_dwordx4 v13, s[12:15], s25 offen lds
    ds_read_b64_tr_b16 v[172:173], v6 offset:18432
    ds_read_b64_tr_b16 v[174:175], v6 offset:19456
    v_mfma_f32_32x32x16_bf16 v[96:111], a[48:51], v[144:147], v[96:111]
    v_mfma_f32_32x32x16_bf16 v[112:127], a[48:51], v[148:151], v[112:127]
    buffer_load_dwordx4 a[16:19], v2, s[8:11], s24 offen offset:0 sc1
    s_waitcnt lgkmcnt(0)
    v_mfma_f32_32x32x16_bf16 v[32:47], v[152:155], a[52:55], v[32:47]
    ds_read_b64_tr_b16 v[128:129], v5 offset:4096
    ds_read_b64_tr_b16 v[130:131], v5 offset:5120
    ds_read_b64_tr_b16 v[132:133], v6 offset:4096
    v_mfma_f32_32x32x16_bf16 v[48:63], v[156:159], a[52:55], v[48:63]
    ds_read_b64_tr_b16 v[134:135], v6 offset:5120
    ds_read_b64_tr_b16 v[136:137], v5 offset:12288
    ds_read_b64_tr_b16 v[138:139], v5 offset:13312
    buffer_load_dwordx4 a[20:23], v2, s[8:11], s24 offen offset:1024 sc1
    v_mfma_f32_32x32x16_bf16 v[64:79], v[160:163], a[52:55], v[64:79]
    ds_read_b64_tr_b16 v[140:141], v6 offset:12288
    ds_read_b64_tr_b16 v[142:143], v6 offset:13312
    ds_read_b64_tr_b16 v[144:145], v5 offset:20480
    v_mfma_f32_32x32x16_bf16 v[80:95], v[164:167], a[52:55], v[80:95]
    ds_read_b64_tr_b16 v[146:147], v5 offset:21504
    ds_read_b64_tr_b16 v[148:149], v6 offset:20480
    ds_read_b64_tr_b16 v[150:151], v6 offset:21504
    buffer_load_dwordx4 a[24:27], v2, s[8:11], s24 offen offset:2048 sc1
    v_mfma_f32_32x32x16_bf16 v[96:111], a[52:55], v[168:171], v[96:111]
    v_mfma_f32_32x32x16_bf16 v[112:127], a[52:55], v[172:175], v[112:127]
    buffer_load_dwordx4 a[28:31], v2, s[8:11], s24 offen offset:3072 sc1
    s_waitcnt lgkmcnt(0)
    v_mfma_f32_32x32x16_bf16 v[32:47], v[128:131], a[56:59], v[32:47]
    ds_read_b64_tr_b16 v[152:153], v5 offset:6144
    ds_read_b64_tr_b16 v[154:155], v5 offset:7168
    ds_read_b64_tr_b16 v[156:157], v6 offset:6144
    v_mfma_f32_32x32x16_bf16 v[48:63], v[132:135], a[56:59], v[48:63]
    ds_read_b64_tr_b16 v[158:159], v6 offset:7168
    ds_read_b64_tr_b16 v[160:161], v5 offset:14336
    ds_read_b64_tr_b16 v[162:163], v5 offset:15360
    v_mfma_f32_32x32x16_bf16 v[64:79], v[136:139], a[56:59], v[64:79]
    ds_read_b64_tr_b16 v[164:165], v6 offset:14336
    ds_read_b64_tr_b16 v[166:167], v6 offset:15360
    ds_read_b64_tr_b16 v[168:169], v5 offset:22528
    v_mfma_f32_32x32x16_bf16 v[80:95], v[140:143], a[56:59], v[80:95]
    ds_read_b64_tr_b16 v[170:171], v5 offset:23552
    ds_read_b64_tr_b16 v[172:173], v6 offset:22528
    ds_read_b64_tr_b16 v[174:175], v6 offset:23552
    v_mfma_f32_32x32x16_bf16 v[96:111], a[56:59], v[144:147], v[96:111]
    v_mfma_f32_32x32x16_bf16 v[112:127], a[56:59], v[148:151], v[112:127]
    s_add_u32 s24, s24, 4096
    s_add_u32 s25, s25, 393216
    s_waitcnt lgkmcnt(0)
    s_waitcnt vmcnt(10)
    s_barrier
    v_add_u32 v5, 0, v3
    v_add_u32 v6, 0, v4
    v_mfma_f32_32x32x16_bf16 v[32:47], v[152:155], a[60:63], v[32:47]
    ds_read_b64_tr_b16 v[128:129], v5 offset:0
    ds_read_b64_tr_b16 v[130:131], v5 offset:1024
    ds_read_b64_tr_b16 v[132:133], v6 offset:0
    v_mfma_f32_32x32x16_bf16 v[48:63], v[156:159], a[60:63], v[48:63]
    s_add_u32 m0, s26, 49152
    ds_read_b64_tr_b16 v[134:135], v6 offset:1024
    buffer_load_dwordx4 v8, s[12:15], s25 offen lds
    ds_read_b64_tr_b16 v[136:137], v5 offset:8192
    ds_read_b64_tr_b16 v[138:139], v5 offset:9216
    v_mfma_f32_32x32x16_bf16 v[64:79], v[160:163], a[60:63], v[64:79]
    ds_read_b64_tr_b16 v[140:141], v6 offset:8192
    ds_read_b64_tr_b16 v[142:143], v6 offset:9216
    ds_read_b64_tr_b16 v[144:145], v5 offset:16384
    v_mfma_f32_32x32x16_bf16 v[80:95], v[164:167], a[60:63], v[80:95]
    s_add_u32 m0, s26, 50176
    ds_read_b64_tr_b16 v[146:147], v5 offset:17408
    buffer_load_dwordx4 v9, s[12:15], s25 offen lds
    ds_read_b64_tr_b16 v[148:149], v6 offset:16384
    ds_read_b64_tr_b16 v[150:151], v6 offset:17408
    v_mfma_f32_32x32x16_bf16 v[96:111], a[60:63], v[168:171], v[96:111]
    v_mfma_f32_32x32x16_bf16 v[112:127], a[60:63], v[172:175], v[112:127]
    s_add_u32 m0, s26, 57344
    s_nop 0
    buffer_load_dwordx4 v10, s[12:15], s25 offen lds
    s_sub_u32 s27, s27, 1
    s_cmp_lg_u32 s27, 0
    s_cbranch_scc1 LOOP_11
    s_waitcnt vmcnt(0) lgkmcnt(0)
    s_mov_b32 s36, 0x3e8293ee
    s_mov_b32 s37, 0x3e8293ee
    s_add_u32 s48, s4, 9437184
    s_addc_u32 s49, s5, 0
    s_and_b32 s49, s49, 0xffff
    s_mov_b32 s50, 12582912
    s_mov_b32 s51, 0x20000
    s_lshl_b32 s38, s38, 7
    s_add_u32 s38, s38, s23
    s_lshl_b32 s38, s38, 11
    s_lshl_b32 s39, s39, 7
    s_add_u32 s39, s39, s23
    s_lshl_b32 s39, s39, 11
    s_lshl_b32 s40, s40, 7
    s_add_u32 s40, s40, s23
    s_lshl_b32 s40, s40, 11
    s_add_u32 s17, s38, 0
    v_pk_mul_f32 v[32:33], v[32:33], s[36:37]
    v_pk_mul_f32 v[34:35], v[34:35], s[36:37]
    v_pk_mul_f32 v[36:37], v[36:37], s[36:37]
    v_pk_mul_f32 v[38:39], v[38:39], s[36:37]
    v_pk_mul_f32 v[40:41], v[40:41], s[36:37]
    v_pk_mul_f32 v[42:43], v[42:43], s[36:37]
    v_pk_mul_f32 v[44:45], v[44:45], s[36:37]
    v_pk_mul_f32 v[46:47], v[46:47], s[36:37]
    v_cvt_pk_bf16_f32 v128, v32, v33
    v_cvt_pk_bf16_f32 v129, v34, v35
    v_cvt_pk_bf16_f32 v130, v36, v37
    v_cvt_pk_bf16_f32 v131, v38, v39
    v_cvt_pk_bf16_f32 v132, v40, v41
    v_cvt_pk_bf16_f32 v133, v42, v43
    v_cvt_pk_bf16_f32 v134, v44, v45
    v_cvt_pk_bf16_f32 v135, v46, v47
    buffer_store_dwordx4 v[128:131], v2, s[48:51], s17 offen sc1
    buffer_store_dwordx4 v[132:135], v2, s[48:51], s17 offen offset:1024 sc1
    s_add_u32 s17, s38, 131072
    v_pk_mul_f32 v[48:49], v[48:49], s[36:37]
    v_pk_mul_f32 v[50:51], v[50:51], s[36:37]
    v_pk_mul_f32 v[52:53], v[52:53], s[36:37]
    v_pk_mul_f32 v[54:55], v[54:55], s[36:37]
    v_pk_mul_f32 v[56:57], v[56:57], s[36:37]
    v_pk_mul_f32 v[58:59], v[58:59], s[36:37]
    v_pk_mul_f32 v[60:61], v[60:61], s[36:37]
    v_pk_mul_f32 v[62:63], v[62:63], s[36:37]
    v_cvt_pk_bf16_f32 v136, v48, v49
    v_cvt_pk_bf16_f32 v137, v50, v51
    v_cvt_pk_bf16_f32 v138, v52, v53
    v_cvt_pk_bf16_f32 v139, v54, v55
    v_cvt_pk_bf16_f32 v140, v56, v57
    v_cvt_pk_bf16_f32 v141, v58, v59
    v_cvt_pk_bf16_f32 v142, v60, v61
    v_cvt_pk_bf16_f32 v143, v62, v63
    buffer_store_dwordx4 v[136:139], v2, s[48:51], s17 offen sc1
    buffer_store_dwordx4 v[140:143], v2, s[48:51], s17 offen offset:1024 sc1
    s_add_u32 s17, s39, 4194304
    v_cvt_pk_bf16_f32 v128, v64, v65
    v_cvt_pk_bf16_f32 v129, v66, v67
    v_cvt_pk_bf16_f32 v130, v68, v69
    v_cvt_pk_bf16_f32 v131, v70, v71
    v_cvt_pk_bf16_f32 v132, v72, v73
    v_cvt_pk_bf16_f32 v133, v74, v75
    v_cvt_pk_bf16_f32 v134, v76, v77
    v_cvt_pk_bf16_f32 v135, v78, v79
    buffer_store_dwordx4 v[128:131], v2, s[48:51], s17 offen sc1
    buffer_store_dwordx4 v[132:135], v2, s[48:51], s17 offen offset:1024 sc1
    s_add_u32 s17, s39, 4325376
    v_cvt_pk_bf16_f32 v136, v80, v81
    v_cvt_pk_bf16_f32 v137, v82, v83
    v_cvt_pk_bf16_f32 v138, v84, v85
    v_cvt_pk_bf16_f32 v139, v86, v87
    v_cvt_pk_bf16_f32 v140, v88, v89
    v_cvt_pk_bf16_f32 v141, v90, v91
    v_cvt_pk_bf16_f32 v142, v92, v93
    v_cvt_pk_bf16_f32 v143, v94, v95
    buffer_store_dwordx4 v[136:139], v2, s[48:51], s17 offen sc1
    buffer_store_dwordx4 v[140:143], v2, s[48:51], s17 offen offset:1024 sc1
    s_add_u32 s17, s40, 8388608
    v_cvt_pk_bf16_f32 v128, v96, v97
    v_cvt_pk_bf16_f32 v129, v98, v99
    v_cvt_pk_bf16_f32 v130, v100, v101
    v_cvt_pk_bf16_f32 v131, v102, v103
    v_cvt_pk_bf16_f32 v132, v104, v105
    v_cvt_pk_bf16_f32 v133, v106, v107
    v_cvt_pk_bf16_f32 v134, v108, v109
    v_cvt_pk_bf16_f32 v135, v110, v111
    buffer_store_dwordx4 v[128:131], v2, s[48:51], s17 offen sc1
    buffer_store_dwordx4 v[132:135], v2, s[48:51], s17 offen offset:1024 sc1
    s_add_u32 s17, s40, 8519680
    v_cvt_pk_bf16_f32 v136, v112, v113
    v_cvt_pk_bf16_f32 v137, v114, v115
    v_cvt_pk_bf16_f32 v138, v116, v117
    v_cvt_pk_bf16_f32 v139, v118, v119
    v_cvt_pk_bf16_f32 v140, v120, v121
    v_cvt_pk_bf16_f32 v141, v122, v123
    v_cvt_pk_bf16_f32 v142, v124, v125
    v_cvt_pk_bf16_f32 v143, v126, v127
    buffer_store_dwordx4 v[136:139], v2, s[48:51], s17 offen sc1
    buffer_store_dwordx4 v[140:143], v2, s[48:51], s17 offen offset:1024 sc1
END_5:
    s_endpgm
.globl amega_kernel
.p2align 8
.type amega_kernel,@function
amega_kernel:
    s_cmp_ge_u32 s2, 256
    s_cbranch_scc1 END_16
    s_load_dwordx2 s[4:5], s[0:1], 80
    s_load_dwordx2 s[6:7], s[0:1], 32
    s_load_dwordx2 s[34:35], s[0:1], 40
    s_load_dwordx2 s[36:37], s[0:1], 16
    s_cmp_ge_u32 s2, 64
    s_cbranch_scc1 NOSCP_27
    s_getpc_b64 s[96:97]
PC_26:
    s_sub_u32 s96, s96, PC_26-amega_kernel
    s_subb_u32 s97, s97, 0
    s_lshr_b32 s98, s2, 3
    s_lshl_b32 s98, s98, 12
    v_lshlrev_b32 v206, 4, v0
    v_add_u32 v206, s98, v206
    v_cmp_gt_u32 vcc, END_16-amega_kernel-16, v206
    v_mov_b32 v205, s97
    v_add_co_u32 v204, s[98:99], s96, v206
    s_nop 1
    v_addc_co_u32 v205, s[98:99], 0, v205, s[98:99]
    s_and_saveexec_b64 s[98:99], vcc
    s_cbranch_execz NOSCP_27x
    global_load_dwordx4 v[200:203], v[204:205], off
NOSCP_27x:
    s_mov_b64 exec, s[98:99]
NOSCP_27:
    v_lshrrev_b32 v6, 6, v0
    v_and_b32 v1, 63, v0
    v_readfirstlane_b32 s22, v6
    s_and_b32 s16, s2, 7
    s_lshr_b32 s17, s2, 3
    s_lshl_b32 s20, s16, 2
    s_lshr_b32 s18, s17, 3
    s_add_u32 s20, s20, s18
    s_and_b32 s21, s17, 7
    s_lshl_b32 s23, s21, 3
    s_lshl_b32 s18, s22, 1
    s_add_u32 s23, s23, s18
    v_lshlrev_b32 v2, 4, v1
    s_lshl_b32 s16, s20, 17
    s_lshl_b32 s17, s23, 11
    s_add_u32 s17, s17, s16
    s_mul_i32 s26, s22, 4096
    s_add_u32 s33, s26, 8192
    s_mov_b32 s24, s26
    v_add_u32 v192, 0, v2
    v_add_u32 v193, 1024, v2
    v_add_u32 v194, 2048, v2
    v_add_u32 v195, 3072, v2
    s_mov_b32 s29, s17
    s_waitcnt lgkmcnt(0)
    s_mov_b64 s[96:97], s[36:37]
    s_mov_b64 s[98:99], s[6:7]
    s_mov_b64 s[100:101], s[34:35]
    s_add_u32 s8, s4, s16
    s_addc_u32 s9, s5, 0
    s_add_u32 s8, s8, 13631488
    s_addc_u32 s9, s9, 0
    s_and_b32 s9, s9, 0xffff
    s_mov_b32 s10, 131072
    s_mov_b32 s11, 0x20000
    s_add_u32 s12, s4, s16
    s_addc_u32 s13, s5, 0
    s_add_u32 s12, s12, 17825792
    s_addc_u32 s13, s13, 0
    s_and_b32 s13, s13, 0xffff
    s_mov_b32 s14, 131072
    s_mov_b32 s15, 0x20000
    s_add_u32 s16, s4, s29
    s_addc_u32 s17, s5, 0
    s_add_u32 s16, s16, 9437184
    s_addc_u32 s17, s17, 0
    s_and_b32 s17, s17, 0xffff
    s_mov_b32 s18, 4096
    s_mov_b32 s19, 0x20000
    s_add_u32 m0, s33, 0
    s_nop 0
    buffer_load_dwordx4 v192, s[8:11], s24 offen lds
    s_add_u32 m0, s33, 1024
    s_nop 0
    buffer_load_dwordx4 v193, s[8:11], s24 offen lds
    s_add_u32 m0, s33, 2048
    s_nop 0
    buffer_load_dwordx4 v194, s[8:11], s24 offen lds
    s_add_u32 m0, s33, 3072
    s_nop 0
    buffer_load_dwordx4 v195, s[8:11], s24 offen lds
    buffer_load_dwordx4 v[10:13], v2, s[16:19], 0 offen
    buffer_load_dwordx4 v[14:17], v2, s[16:19], 0 offen offset:1024
    buffer_load_dwordx4 v[18:21], v2, s[16:19], 0 offen offset:2048
    buffer_load_dwordx4 v[22:25], v2, s[16:19], 0 offen offset:3072
    s_add_u32 m0, s33, 16384
    s_nop 0
    buffer_load_dwordx4 v192, s[12:15], s24 offen lds
    s_add_u32 m0, s33, 17408
    s_nop 0
    buffer_load_dwordx4 v193, s[12:15], s24 offen lds
    s_add_u32 m0, s33, 18432
    s_nop 0
    buffer_load_dwordx4 v194, s[12:15], s24 offen lds
    s_add_u32 m0, s33, 19456
    s_nop 0
    buffer_load_dwordx4 v195, s[12:15], s24 offen lds
    s_add_u32 s24, s24, 16384
    s_mul_hi_u32 s44, s2, 76695845
    s_mul_i32 s45, s44, 56
    s_sub_u32 s45, s2, s45
    s_lshl_b32 s46, s44, 8
    s_lshl_b32 s38, s22, 6
    s_add_u32 s46, s46, s38
    s_mul_i32 s38, s46, 7168
    s_lshl_b32 s39, s45, 7
    s_add_u32 s38, s38, s39
    s_add_u32 s40, s6, s38
    s_addc_u32 s41, s7, 0
    s_and_b32 s41, s41, 0xffff
    s_cmp_lt_u32 s2, 224
    s_cselect_b32 s42, 451712, 0
    s_mov_b32 s43, 0x20000
    s_mov_b32 s47, 0
    s_lshl_b32 s39, s22, 13
    s_add_u32 s39, s39, 106496
    v_lshrrev_b32 v6, 3, v1
    v_bfe_u32 v7, v1, 4, 1
    v_lshlrev_b32 v7, 2, v7
    v_and_b32 v190, 7, v1
    v_xor_b32 v190, v190, v7
    v_lshlrev_b32 v190, 4, v190
    v_mul_u32_u24 v6, 7168, v6
    v_add_u32 v190, v190, v6
    s_lshl_b32 s38, s2, 2
    s_add_u32 s38, s38, s22
    s_mul_i32 s50, s38, 7168
    s_add_u32 s52, s34, s50
    s_addc_u32 s53, s35, 0
    s_and_b32 s53, s53, 0xffff
    s_mov_b32 s54, 7168
    s_mov_b32 s55, 0x20000
    s_lshl_b32 s50, s38, 11
    s_mov_b32 s49, 0
    s_lshl_b32 s48, s22, 10
    s_add_u32 s48, s48, 4096
    v_mov_b32 v191, v2
    s_mov_b32 s56, s36
    s_and_b32 s57, s37, 0xffff
    s_mov_b32 s58, 2097152
    s_mov_b32 s59, 0x20000
    v_lshrrev_b32 v6, 3, v1
    v_bfe_u32 v7, v1, 4, 1
    v_lshlrev_b32 v7, 2, v7
    v_and_b32 v208, 7, v1
    v_xor_b32 v208, v208, v7
    v_lshlrev_b32 v208, 4, v208
    v_mul_u32_u24 v6, 2048, v6
    v_add_u32 v208, v208, v6
    s_and_b32 s50, s2, 1
    s_lshl_b32 s50, s50, 3
    s_bfe_u32 s51, s2, 0x30003
    s_add_u32 s50, s50, s51
    s_lshl_b32 s50, s50, 7
    s_lshl_b32 s51, s22, 16
    s_add_u32 s50, s50, s51
    v_add_u32 v208, s50, v208
    v_add_u32 v209, 16384, v208
    v_add_u32 v210, 32768, v208
    v_add_u32 v211, 49152, v208
    s_mov_b32 s60, s4
    s_and_b32 s61, s5, 0xffff
    s_mov_b32 s62, 24576
    s_mov_b32 s63, 0x20000
    s_lshl_b32 s38, s44, 10
    s_and_b32 s38, s38, 0xfff
    v_lshlrev_b32 v186, 2, v0
    v_add_u32 v186, s38, v186
    v_add_u32 v187, 0x3000, v186
    v_add_u32 v186, 0x4000, v186
    v_and_b32 v6, 7, v1
    v_bfe_u32 v7, v1, 4, 1
    v_lshlrev_b32 v7, 2, v7
    v_cmp_eq_u32 vcc, v6, v7
    v_mov_b32 v8, 0x3f803f80
    v_add_u32 v3, 8192, v2
    v_cndmask_b32 v58, 0, v8, vcc
    v_mov_b32 v59, v58
    v_mov_b32 v60, v58
    v_mov_b32 v61, v58
    s_mov_b32 s28, 0
    v_mov_b32 v6, 3072
    v_mov_b32 v7, 0
    ds_write_b32 v6, v7
    v_mov_b32 v70, 0
    v_mov_b32 v71, 0
    v_mov_b32 v72, 0
    v_mov_b32 v73, 0
    v_mov_b32 v74, 0
    v_mov_b32 v75, 0
    v_mov_b32 v76, 0
    v_mov_b32 v77, 0
    v_mov_b32 v78, 0
    v_mov_b32 v79, 0
    v_mov_b32 v80, 0
    v_mov_b32 v81, 0
    v_mov_b32 v82, 0
    v_mov_b32 v83, 0
    v_mov_b32 v84, 0
    v_mov_b32 v85, 0
    v_mov_b32 v86, 0
    v_mov_b32 v87, 0
    v_mov_b32 v88, 0
    v_mov_b32 v89, 0
    v_mov_b32 v90, 0
    v_mov_b32 v91, 0
    v_mov_b32 v92, 0
    v_mov_b32 v93, 0
    v_mov_b32 v94, 0
    v_mov_b32 v95, 0
    v_mov_b32 v96, 0
    v_mov_b32 v97, 0
    v_mov_b32 v98, 0
    v_mov_b32 v99, 0
    v_mov_b32 v100, 0
    v_mov_b32 v101, 0
    v_mov_b32 v62, 0
    v_mov_b32 v63, 0
    v_mov_b32 v64, 0
    v_mov_b32 v65, 0
    v_mov_b32 v66, 0
    v_mov_b32 v67, 0
    v_mov_b32 v68, 0
    v_mov_b32 v69, 0
    v_mov_b32 v174, 0
    v_mov_b32 v175, 0
    v_mov_b32 v176, 0
    v_mov_b32 v177, 0
    v_mov_b32 v178, 0
    v_mov_b32 v179, 0
    v_mov_b32 v180, 0
    v_mov_b32 v181, 0
    v_mov_b32 v50, 0
    v_mov_b32 v51, 0
    v_mov_b32 v52, 0
    v_mov_b32 v53, 0
    v_mov_b32 v54, 0
    v_mov_b32 v55, 0
    v_mov_b32 v56, 0
    v_mov_b32 v57, 0
    s_waitcnt vmcnt(0) lgkmcnt(0)
    s_barrier
    ds_read_b128 v[26:29], v3 offset:0
    ds_read_b128 v[30:33], v3 offset:1024
    ds_read_b128 v[34:37], v3 offset:2048
    ds_read_b128 v[38:41], v3 offset:3072
    ds_read_b128 v[42:45], v3 offset:16384
    ds_read_b128 v[46:49], v3 offset:17408
    buffer_load_dword v196, v186, s[60:63], 0 offen
    buffer_load_dword v197, v187, s[60:63], 0 offen
    s_waitcnt lgkmcnt(2)
    s_add_u32 m0, s33, 32768
    v_mfma_f32_32x32x16_bf16 v[134:149], v[26:29], v[10:13], 0
    buffer_load_dwordx4 v192, s[8:11], s24 offen lds
    s_add_u32 m0, s33, 33792
    v_mfma_f32_32x32x16_bf16 v[134:149], v[30:33], v[14:17], v[134:149]
    buffer_load_dwordx4 v193, s[8:11], s24 offen lds
    s_add_u32 m0, s33, 34816
    v_mfma_f32_32x32x16_bf16 v[150:165], v[26:29], v[18:21], 0
    buffer_load_dwordx4 v194, s[8:11], s24 offen lds
    s_add_u32 m0, s33, 35840
    v_mfma_f32_32x32x16_bf16 v[150:165], v[30:33], v[22:25], v[150:165]
    buffer_load_dwordx4 v195, s[8:11], s24 offen lds
    s_add_u32 m0, s33, 49152
    v_mfma_f32_32x32x16_bf16 v[102:117], v[34:37], v[10:13], 0
    buffer_load_dwordx4 v192, s[12:15], s24 offen lds
    s_add_u32 m0, s33, 50176
    v_mfma_f32_32x32x16_bf16 v[102:117], v[38:41], v[14:17], v[102:117]
    buffer_load_dwordx4 v193, s[12:15], s24 offen lds
    s_add_u32 m0, s33, 51200
    v_mfma_f32_32x32x16_bf16 v[118:133], v[34:37], v[18:21], 0
    buffer_load_dwordx4 v194, s[12:15], s24 offen lds
    s_add_u32 m0, s33, 52224
    v_mfma_f32_32x32x16_bf16 v[118:133], v[38:41], v[22:25], v[118:133]
    buffer_load_dwordx4 v195, s[12:15], s24 offen lds
    s_add_u32 s24, s24, 16384
    s_cmp_lt_u32 s47, 458752
    s_cselect_b32 m0, s39, s48
    s_add_u32 s39, s39, 1024
    buffer_load_dwordx4 v190, s[40:43], s47 offen lds
    s_add_u32 s47, s47, 57344
    s_mov_b32 m0, s48
    s_nop 0
    buffer_load_dwordx4 v191, s[52:55], s49 offen lds
    s_add_u32 s49, s49, 1024
    v_max3_f32 v182, v134, v135, v136
    v_max3_f32 v182, v182, v137, v138
    v_max3_f32 v182, v182, v139, v140
    v_max3_f32 v182, v182, v141, v142
    v_max3_f32 v182, v182, v143, v144
    v_max3_f32 v182, v182, v145, v146
    v_max3_f32 v182, v182, v147, v148
    v_max_f32 v182, v182, v149
    v_max3_f32 v183, v150, v151, v152
    v_max3_f32 v183, v183, v153, v154
    v_max3_f32 v183, v183, v155, v156
    v_max3_f32 v183, v183, v157, v158
    v_max3_f32 v183, v183, v159, v160
    v_max3_f32 v183, v183, v161, v162
    v_max3_f32 v183, v183, v163, v164
    v_max_f32 v183, v183, v165
    v_max3_f32 v182, v182, v102, v103
    v_max3_f32 v182, v182, v104, v105
    v_max3_f32 v182, v182, v106, v107
    v_max3_f32 v182, v182, v108, v109
    v_max3_f32 v182, v182, v110, v111
    v_max3_f32 v182, v182, v112, v113
    v_max3_f32 v182, v182, v114, v115
    v_max3_f32 v182, v182, v116, v117
    v_max3_f32 v183, v183, v118, v119
    v_max3_f32 v183, v183, v120, v121
    v_max3_f32 v183, v183, v122, v123
    v_max3_f32 v183, v183, v124, v125
    v_max3_f32 v183, v183, v126, v127
    v_max3_f32 v183, v183, v128, v129
    v_max3_f32 v183, v183, v130, v131
    v_max3_f32 v183, v183, v132, v133
GO_25:
    v_mov_b32 v184, v182
    s_nop 1
    v_permlane32_swap_b32 v182, v184
    s_nop 1
    v_max_f32 v182, v182, v184
    v_sub_f32 v182, 0, v182
    v_mov_b32 v184, v183
    s_nop 1
    v_permlane32_swap_b32 v183, v184
    s_nop 1
    v_max_f32 v183, v183, v184
    v_sub_f32 v183, 0, v183
    v_mov_b32 v102, v182
    v_mov_b32 v103, v182
    v_mov_b32 v104, v182
    v_mov_b32 v105, v182
    v_mov_b32 v106, v182
    v_mov_b32 v107, v182
    v_mov_b32 v108, v182
    v_mov_b32 v109, v182
    v_mov_b32 v110, v182
    v_mov_b32 v111, v182
    v_mov_b32 v112, v182
    v_mov_b32 v113, v182
    v_mov_b32 v114, v182
    v_mov_b32 v115, v182
    v_mov_b32 v116, v182
    v_mov_b32 v117, v182
    v_mov_b32 v118, v183
    v_mov_b32 v119, v183
    v_mov_b32 v120, v183
    v_mov_b32 v121, v183
    v_mov_b32 v122, v183
    v_mov_b32 v123, v183
    v_mov_b32 v124, v183
    v_mov_b32 v125, v183
    v_mov_b32 v126, v183
    v_mov_b32 v127, v183
    v_mov_b32 v128, v183
    v_mov_b32 v129, v183
    v_mov_b32 v130, v183
    v_mov_b32 v131, v183
    v_mov_b32 v132, v183
    v_mov_b32 v133, v183
    s_waitcnt lgkmcnt(0)
    v_mfma_f32_32x32x16_bf16 v[134:149], v[26:29], v[10:13], v[102:117]
    v_mfma_f32_32x32x16_bf16 v[134:149], v[30:33], v[14:17], v[134:149]
    s_mov_b32 s25, 0
    s_mov_b32 s27, 8
    v_mov_b32 v4, v3
    s_nop 7
    s_nop 3
LOOP_21:
    v_mfma_f32_32x32x16_bf16 v[150:165], v[26:29], v[18:21], v[118:133]
    v_exp_f32 v134, v134
    v_exp_f32 v135, v135
    v_exp_f32 v136, v136
    v_exp_f32 v137, v137
    v_cvt_pk_bf16_f32 v166, v134, v135
    v_mfma_f32_32x32x16_bf16 v[150:165], v[30:33], v[22:25], v[150:165]
    ds_read_b128 v[26:29], v4 offset:4096
    ds_read_b128 v[30:33], v4 offset:5120
    v_exp_f32 v138, v138
    v_exp_f32 v139, v139
    v_cvt_pk_bf16_f32 v167, v136, v137
    v_exp_f32 v140, v140
    v_mfma_f32_32x32x16_bf16 v[86:101], v[50:53], v[174:177], v[86:101]
    v_exp_f32 v141, v141
    v_cvt_pk_bf16_f32 v168, v138, v139
    v_exp_f32 v142, v142
    v_exp_f32 v143, v143
    v_mfma_f32_32x32x16_bf16 v[86:101], v[54:57], v[178:181], v[86:101]
    ds_read_b128 v[50:53], v4 offset:18432
    ds_read_b128 v[54:57], v4 offset:19456
    v_cvt_pk_bf16_f32 v169, v140, v141
    v_exp_f32 v144, v144
    v_exp_f32 v145, v145
    v_cvt_pk_bf16_f32 v170, v142, v143
    v_mfma_f32_16x16x32_bf16 v[66:69], v[58:61], v[174:177], v[66:69]
    v_exp_f32 v146, v146
    v_exp_f32 v147, v147
    v_cvt_pk_bf16_f32 v171, v144, v145
    v_mfma_f32_16x16x32_bf16 v[66:69], v[58:61], v[178:181], v[66:69]
    v_exp_f32 v148, v148
    v_exp_f32 v149, v149
    v_cvt_pk_bf16_f32 v172, v146, v147
    s_waitcnt lgkmcnt(4)
    v_cvt_pk_bf16_f32 v173, v148, v149
    v_mfma_f32_32x32x16_bf16 v[134:149], v[34:37], v[10:13], v[102:117]
    v_exp_f32 v150, v150
    v_exp_f32 v151, v151
    v_exp_f32 v152, v152
    v_exp_f32 v153, v153
    v_cvt_pk_bf16_f32 v174, v150, v151
    v_mfma_f32_32x32x16_bf16 v[134:149], v[38:41], v[14:17], v[134:149]
    v_exp_f32 v154, v154
    v_exp_f32 v155, v155
    v_cvt_pk_bf16_f32 v175, v152, v153
    v_exp_f32 v156, v156
    v_mfma_f32_32x32x16_bf16 v[70:85], v[42:45], v[166:169], v[70:85]
    v_exp_f32 v157, v157
    v_cvt_pk_bf16_f32 v176, v154, v155
    v_exp_f32 v158, v158
    v_exp_f32 v159, v159
    v_mfma_f32_32x32x16_bf16 v[70:85], v[46:49], v[170:173], v[70:85]
    v_cvt_pk_bf16_f32 v177, v156, v157
    v_exp_f32 v160, v160
    v_exp_f32 v161, v161
    v_cvt_pk_bf16_f32 v178, v158, v159
    v_mfma_f32_16x16x32_bf16 v[62:65], v[58:61], v[166:169], v[62:65]
    v_exp_f32 v162, v162
    v_exp_f32 v163, v163
    v_cvt_pk_bf16_f32 v179, v160, v161
    v_mfma_f32_16x16x32_bf16 v[62:65], v[58:61], v[170:173], v[62:65]
    v_exp_f32 v164, v164
    v_exp_f32 v165, v165
    v_cvt_pk_bf16_f32 v180, v162, v163
    v_cvt_pk_bf16_f32 v181, v164, v165
    v_mfma_f32_32x32x16_bf16 v[150:165], v[34:37], v[18:21], v[118:133]
    v_exp_f32 v134, v134
    v_exp_f32 v135, v135
    v_exp_f32 v136, v136
    v_exp_f32 v137, v137
    v_cvt_pk_bf16_f32 v166, v134, v135
    v_mfma_f32_32x32x16_bf16 v[150:165], v[38:41], v[22:25], v[150:165]
    ds_read_b128 v[34:37], v4 offset:6144
    ds_read_b128 v[38:41], v4 offset:7168
    v_exp_f32 v138, v138
    v_exp_f32 v139, v139
    v_cvt_pk_bf16_f32 v167, v136, v137
    v_exp_f32 v140, v140
    v_mfma_f32_32x32x16_bf16 v[86:101], v[42:45], v[174:177], v[86:101]
    v_exp_f32 v141, v141
    v_cvt_pk_bf16_f32 v168, v138, v139
    v_exp_f32 v142, v142
    v_exp_f32 v143, v143
    v_mfma_f32_32x32x16_bf16 v[86:101], v[46:49], v[178:181], v[86:101]
    ds_read_b128 v[42:45], v4 offset:20480
    ds_read_b128 v[46:49], v4 offset:21504
    v_cvt_pk_bf16_f32 v169, v140, v141
    v_exp_f32 v144, v144
    v_exp_f32 v145, v145
    v_cvt_pk_bf16_f32 v170, v142, v143
    v_mfma_f32_16x16x32_bf16 v[66:69], v[58:61], v[174:177], v[66:69]
    v_exp_f32 v146, v146
    v_exp_f32 v147, v147
    v_cvt_pk_bf16_f32 v171, v144, v145
    v_mfma_f32_16x16x32_bf16 v[66:69], v[58:61], v[178:181], v[66:69]
    v_exp_f32 v148, v148
    v_exp_f32 v149, v149
    v_cvt_pk_bf16_f32 v172, v146, v147
    s_waitcnt lgkmcnt(4)
    v_cvt_pk_bf16_f32 v173, v148, v149
    v_mfma_f32_32x32x16_bf16 v[134:149], v[26:29], v[10:13], v[102:117]
    v_exp_f32 v150, v150
    v_exp_f32 v151, v151
    v_exp_f32 v152, v152
    v_exp_f32 v153, v153
    v_cvt_pk_bf16_f32 v174, v150, v151
    v_mfma_f32_32x32x16_bf16 v[134:149], v[30:33], v[14:17], v[134:149]
    v_exp_f32 v154, v154
    v_exp_f32 v155, v155
    v_cvt_pk_bf16_f32 v175, v152, v153
    v_exp_f32 v156, v156
    v_mfma_f32_32x32x16_bf16 v[70:85], v[50:53], v[166:169], v[70:85]
    v_exp_f32 v157, v157
    v_cvt_pk_bf16_f32 v176, v154, v155
    v_exp_f32 v158, v158
    v_exp_f32 v159, v159
    v_mfma_f32_32x32x16_bf16 v[70:85], v[54:57], v[170:173], v[70:85]
    v_cvt_pk_bf16_f32 v177, v156, v157
    v_exp_f32 v160, v160
    v_exp_f32 v161, v161
    v_cvt_pk_bf16_f32 v178, v158, v159
    v_mfma_f32_16x16x32_bf16 v[62:65], v[58:61], v[166:169], v[62:65]
    v_exp_f32 v162, v162
    v_exp_f32 v163, v163
    v_cvt_pk_bf16_f32 v179, v160, v161
    v_mfma_f32_16x16x32_bf16 v[62:65], v[58:61], v[170:173], v[62:65]
    v_exp_f32 v164, v164
    v_exp_f32 v165, v165
    v_cvt_pk_bf16_f32 v180, v162, v163
    v_cvt_pk_bf16_f32 v181, v164, v165
    v_mfma_f32_32x32x16_bf16 v[150:165], v[26:29], v[18:21], v[118:133]
    v_exp_f32 v134, v134
    v_exp_f32 v135, v135
    v_exp_f32 v136, v136
    v_exp_f32 v137, v137
    v_cvt_pk_bf16_f32 v166, v134, v135
    v_mfma_f32_32x32x16_bf16 v[150:165], v[30:33], v[22:25], v[150:165]
    ds_read_b128 v[26:29], v4 offset:8192
    ds_read_b128 v[30:33], v4 offset:9216
    v_exp_f32 v138, v138
    v_exp_f32 v139, v139
    v_cvt_pk_bf16_f32 v167, v136, v137
    v_exp_f32 v140, v140
    v_mfma_f32_32x32x16_bf16 v[86:101], v[50:53], v[174:177], v[86:101]
    v_exp_f32 v141, v141
    v_cvt_pk_bf16_f32 v168, v138, v139
    v_exp_f32 v142, v142
    v_exp_f32 v143, v143
    v_mfma_f32_32x32x16_bf16 v[86:101], v[54:57], v[178:181], v[86:101]
    ds_read_b128 v[50:53], v4 offset:22528
    ds_read_b128 v[54:57], v4 offset:23552
    v_cvt_pk_bf16_f32 v169, v140, v141
    v_exp_f32 v144, v144
    v_exp_f32 v145, v145
    v_cvt_pk_bf16_f32 v170, v142, v143
    v_mfma_f32_16x16x32_bf16 v[66:69], v[58:61], v[174:177], v[66:69]
    v_exp_f32 v146, v146
    v_exp_f32 v147, v147
    v_cvt_pk_bf16_f32 v171, v144, v145
    v_mfma_f32_16x16x32_bf16 v[66:69], v[58:61], v[178:181], v[66:69]
    v_exp_f32 v148, v148
    v_exp_f32 v149, v149
    v_cvt_pk_bf16_f32 v172, v146, v147
    s_waitcnt lgkmcnt(4)
    v_cvt_pk_bf16_f32 v173, v148, v149
    v_mfma_f32_32x32x16_bf16 v[134:149], v[34:37], v[10:13], v[102:117]
    v_exp_f32 v150, v150
    v_exp_f32 v151, v151
    v_exp_f32 v152, v152
    v_exp_f32 v153, v153
    v_cvt_pk_bf16_f32 v174, v150, v151
    v_mfma_f32_32x32x16_bf16 v[134:149], v[38:41], v[14:17], v[134:149]
    v_exp_f32 v154, v154
    v_exp_f32 v155, v155
    v_cvt_pk_bf16_f32 v175, v152, v153
    v_exp_f32 v156, v156
    v_mfma_f32_32x32x16_bf16 v[70:85], v[42:45], v[166:169], v[70:85]
    v_exp_f32 v157, v157
    v_cvt_pk_bf16_f32 v176, v154, v155
    v_exp_f32 v158, v158
    v_exp_f32 v159, v159
    v_mfma_f32_32x32x16_bf16 v[70:85], v[46:49], v[170:173], v[70:85]
    v_cvt_pk_bf16_f32 v177, v156, v157
    v_exp_f32 v160, v160
    v_exp_f32 v161, v161
    v_cvt_pk_bf16_f32 v178, v158, v159
    v_mfma_f32_16x16x32_bf16 v[62:65], v[58:61], v[166:169], v[62:65]
    v_exp_f32 v162, v162
    v_exp_f32 v163, v163
    v_cvt_pk_bf16_f32 v179, v160, v161
    v_mfma_f32_16x16x32_bf16 v[62:65], v[58:61], v[170:173], v[62:65]
    v_exp_f32 v164, v164
    v_exp_f32 v165, v165
    v_cvt_pk_bf16_f32 v180, v162, v163
    v_cvt_pk_bf16_f32 v181, v164, v165
    v_mfma_f32_32x32x16_bf16 v[150:165], v[34:37], v[18:21], v[118:133]
    v_exp_f32 v134, v134
    v_exp_f32 v135, v135
    v_exp_f32 v136, v136
    v_exp_f32 v137, v137
    v_cvt_pk_bf16_f32 v166, v134, v135
    v_mfma_f32_32x32x16_bf16 v[150:165], v[38:41], v[22:25], v[150:165]
    ds_read_b128 v[34:37], v4 offset:10240
    ds_read_b128 v[38:41], v4 offset:11264
    v_exp_f32 v138, v138
    v_exp_f32 v139, v139
    v_cvt_pk_bf16_f32 v167, v136, v137
    v_exp_f32 v140, v140
    v_mfma_f32_32x32x16_bf16 v[86:101], v[42:45], v[174:177], v[86:101]
    v_exp_f32 v141, v141
    v_cvt_pk_bf16_f32 v168, v138, v139
    v_exp_f32 v142, v142
    v_exp_f32 v143, v143
    v_mfma_f32_32x32x16_bf16 v[86:101], v[46:49], v[178:181], v[86:101]
    ds_read_b128 v[42:45], v4 offset:24576
    ds_read_b128 v[46:49], v4 offset:25600
    v_cvt_pk_bf16_f32 v169, v140, v141
    v_exp_f32 v144, v144
    v_exp_f32 v145, v145
    v_cvt_pk_bf16_f32 v170, v142, v143
    v_mfma_f32_16x16x32_bf16 v[66:69], v[58:61], v[174:177], v[66:69]
    v_exp_f32 v146, v146
    v_exp_f32 v147, v147
    v_cvt_pk_bf16_f32 v171, v144, v145
    v_mfma_f32_16x16x32_bf16 v[66:69], v[58:61], v[178:181], v[66:69]
    v_exp_f32 v148, v148
    v_exp_f32 v149, v149
    v_cvt_pk_bf16_f32 v172, v146, v147
    s_waitcnt lgkmcnt(4)
    v_cvt_pk_bf16_f32 v173, v148, v149
    v_mfma_f32_32x32x16_bf16 v[134:149], v[26:29], v[10:13], v[102:117]
    v_exp_f32 v150, v150
    v_exp_f32 v151, v151
    v_exp_f32 v152, v152
    v_exp_f32 v153, v153
    v_cvt_pk_bf16_f32 v174, v150, v151
    v_mfma_f32_32x32x16_bf16 v[134:149], v[30:33], v[14:17], v[134:149]
    v_exp_f32 v154, v154
    v_exp_f32 v155, v155
    v_cvt_pk_bf16_f32 v175, v152, v153
    v_exp_f32 v156, v156
    v_mfma_f32_32x32x16_bf16 v[70:85], v[50:53], v[166:169], v[70:85]
    v_exp_f32 v157, v157
    v_cvt_pk_bf16_f32 v176, v154, v155
    v_exp_f32 v158, v158
    v_exp_f32 v159, v159
    v_mfma_f32_32x32x16_bf16 v[70:85], v[54:57], v[170:173], v[70:85]
    v_cvt_pk_bf16_f32 v177, v156, v157
    v_exp_f32 v160, v160
    v_exp_f32 v161, v161
    v_cvt_pk_bf16_f32 v178, v158, v159
    v_mfma_f32_16x16x32_bf16 v[62:65], v[58:61], v[166:169], v[62:65]
    v_exp_f32 v162, v162
    v_exp_f32 v163, v163
    v_cvt_pk_bf16_f32 v179, v160, v161
    v_mfma_f32_16x16x32_bf16 v[62:65], v[58:61], v[170:173], v[62:65]
    v_exp_f32 v164, v164
    v_exp_f32 v165, v165
    v_cvt_pk_bf16_f32 v180, v162, v163
    v_cvt_pk_bf16_f32 v181, v164, v165
    v_mfma_f32_32x32x16_bf16 v[150:165], v[26:29], v[18:21], v[118:133]
    v_exp_f32 v134, v134
    v_exp_f32 v135, v135
    v_exp_f32 v136, v136
    v_exp_f32 v137, v137
    v_cvt_pk_bf16_f32 v166, v134, v135
    v_mfma_f32_32x32x16_bf16 v[150:165], v[30:33], v[22:25], v[150:165]
    ds_read_b128 v[26:29], v4 offset:12288
    ds_read_b128 v[30:33], v4 offset:13312
    v_exp_f32 v138, v138
    v_exp_f32 v139, v139
    v_cvt_pk_bf16_f32 v167, v136, v137
    v_exp_f32 v140, v140
    v_mfma_f32_32x32x16_bf16 v[86:101], v[50:53], v[174:177], v[86:101]
    v_exp_f32 v141, v141
    v_cvt_pk_bf16_f32 v168, v138, v139
    v_exp_f32 v142, v142
    v_exp_f32 v143, v143
    v_mfma_f32_32x32x16_bf16 v[86:101], v[54:57], v[178:181], v[86:101]
    ds_read_b128 v[50:53], v4 offset:26624
    ds_read_b128 v[54:57], v4 offset:27648
    v_cvt_pk_bf16_f32 v169, v140, v141
    v_exp_f32 v144, v144
    v_exp_f32 v145, v145
    v_cvt_pk_bf16_f32 v170, v142, v143
    v_mfma_f32_16x16x32_bf16 v[66:69], v[58:61], v[174:177], v[66:69]
    v_exp_f32 v146, v146
    v_exp_f32 v147, v147
    v_cvt_pk_bf16_f32 v171, v144, v145
    v_mfma_f32_16x16x32_bf16 v[66:69], v[58:61], v[178:181], v[66:69]
    v_exp_f32 v148, v148
    v_exp_f32 v149, v149
    v_cvt_pk_bf16_f32 v172, v146, v147
    s_waitcnt lgkmcnt(4)
    v_cvt_pk_bf16_f32 v173, v148, v149
    v_mfma_f32_32x32x16_bf16 v[134:149], v[34:37], v[10:13], v[102:117]
    v_exp_f32 v150, v150
    v_exp_f32 v151, v151
    v_exp_f32 v152, v152
    v_exp_f32 v153, v153
    v_cvt_pk_bf16_f32 v174, v150, v151
    v_mfma_f32_32x32x16_bf16 v[134:149], v[38:41], v[14:17], v[134:149]
    v_exp_f32 v154, v154
    v_exp_f32 v155, v155
    v_cvt_pk_bf16_f32 v175, v152, v153
    v_exp_f32 v156, v156
    v_mfma_f32_32x32x16_bf16 v[70:85], v[42:45], v[166:169], v[70:85]
    v_exp_f32 v157, v157
    v_cvt_pk_bf16_f32 v176, v154, v155
    v_exp_f32 v158, v158
    v_exp_f32 v159, v159
    v_mfma_f32_32x32x16_bf16 v[70:85], v[46:49], v[170:173], v[70:85]
    v_cvt_pk_bf16_f32 v177, v156, v157
    v_exp_f32 v160, v160
    v_exp_f32 v161, v161
    v_cvt_pk_bf16_f32 v178, v158, v159
    v_mfma_f32_16x16x32_bf16 v[62:65], v[58:61], v[166:169], v[62:65]
    v_exp_f32 v162, v162
    v_exp_f32 v163, v163
    v_cvt_pk_bf16_f32 v179, v160, v161
    v_mfma_f32_16x16x32_bf16 v[62:65], v[58:61], v[170:173], v[62:65]
    v_exp_f32 v164, v164
    v_exp_f32 v165, v165
    v_cvt_pk_bf16_f32 v180, v162, v163
    v_cvt_pk_bf16_f32 v181, v164, v165
    v_mfma_f32_32x32x16_bf16 v[150:165], v[34:37], v[18:21], v[118:133]
    v_exp_f32 v134, v134
    v_exp_f32 v135, v135
    v_exp_f32 v136, v136
    v_exp_f32 v137, v137
    v_cvt_pk_bf16_f32 v166, v134, v135
    v_mfma_f32_32x32x16_bf16 v[150:165], v[38:41], v[22:25], v[150:165]
    ds_read_b128 v[34:37], v4 offset:14336
    ds_read_b128 v[38:41], v4 offset:15360
    v_exp_f32 v138, v138
    v_exp_f32 v139, v139
    v_cvt_pk_bf16_f32 v167, v136, v137
    v_exp_f32 v140, v140
    v_mfma_f32_32x32x16_bf16 v[86:101], v[42:45], v[174:177], v[86:101]
    v_exp_f32 v141, v141
    v_cvt_pk_bf16_f32 v168, v138, v139
    v_exp_f32 v142, v142
    v_exp_f32 v143, v143
    v_mfma_f32_32x32x16_bf16 v[86:101], v[46:49], v[178:181], v[86:101]
    ds_read_b128 v[42:45], v4 offset:28672
    ds_read_b128 v[46:49], v4 offset:29696
    v_cvt_pk_bf16_f32 v169, v140, v141
    v_exp_f32 v144, v144
    v_exp_f32 v145, v145
    v_cvt_pk_bf16_f32 v170, v142, v143
    v_mfma_f32_16x16x32_bf16 v[66:69], v[58:61], v[174:177], v[66:69]
    s_add_u32 s29, s25, 65536
    s_cmp_ge_u32 s29, 98304
    s_cselect_b32 s30, 98304, 0
    s_sub_u32 s29, s29, s30
    s_add_u32 s29, s29, s33
    v_exp_f32 v146, v146
    v_exp_f32 v147, v147
    v_cvt_pk_bf16_f32 v171, v144, v145
    v_mfma_f32_16x16x32_bf16 v[66:69], v[58:61], v[178:181], v[66:69]
    s_add_u32 s31, s25, 32768
    s_cmp_ge_u32 s31, 98304
    s_cselect_b32 s31, 0, s31
    v_add_u32 v5, s31, v3
    v_exp_f32 v148, v148
    v_exp_f32 v149, v149
    v_cvt_pk_bf16_f32 v172, v146, v147
    s_waitcnt lgkmcnt(4)
    v_cvt_pk_bf16_f32 v173, v148, v149
    v_mfma_f32_32x32x16_bf16 v[134:149], v[26:29], v[10:13], v[102:117]
    v_exp_f32 v150, v150
    v_exp_f32 v151, v151
    v_exp_f32 v152, v152
    v_exp_f32 v153, v153
    v_cvt_pk_bf16_f32 v174, v150, v151
    v_mfma_f32_32x32x16_bf16 v[134:149], v[30:33], v[14:17], v[134:149]
    v_exp_f32 v154, v154
    v_exp_f32 v155, v155
    v_cvt_pk_bf16_f32 v175, v152, v153
    v_exp_f32 v156, v156
    v_mfma_f32_32x32x16_bf16 v[70:85], v[50:53], v[166:169], v[70:85]
    v_exp_f32 v157, v157
    v_cvt_pk_bf16_f32 v176, v154, v155
    v_exp_f32 v158, v158
    v_exp_f32 v159, v159
    v_mfma_f32_32x32x16_bf16 v[70:85], v[54:57], v[170:173], v[70:85]
    v_cvt_pk_bf16_f32 v177, v156, v157
    v_exp_f32 v160, v160
    v_exp_f32 v161, v161
    v_cvt_pk_bf16_f32 v178, v158, v159
    v_mfma_f32_16x16x32_bf16 v[62:65], v[58:61], v[166:169], v[62:65]
    v_exp_f32 v162, v162
    v_exp_f32 v163, v163
    v_cvt_pk_bf16_f32 v179, v160, v161
    v_mfma_f32_16x16x32_bf16 v[62:65], v[58:61], v[170:173], v[62:65]
    v_exp_f32 v164, v164
    v_exp_f32 v165, v165
    v_cvt_pk_bf16_f32 v180, v162, v163
    v_cvt_pk_bf16_f32 v181, v164, v165
    s_waitcnt vmcnt(2)
    s_barrier
    v_mfma_f32_32x32x16_bf16 v[150:165], v[26:29], v[18:21], v[118:133]
    s_add_u32 m0, s29, 0
    v_exp_f32 v134, v134
    v_exp_f32 v135, v135
    v_exp_f32 v136, v136
    v_exp_f32 v137, v137
    v_cvt_pk_bf16_f32 v166, v134, v135
    v_mfma_f32_32x32x16_bf16 v[150:165], v[30:33], v[22:25], v[150:165]
    ds_read_b128 v[26:29], v5 offset:0
    ds_read_b128 v[30:33], v5 offset:1024
    buffer_load_dwordx4 v192, s[8:11], s24 offen lds
    v_exp_f32 v138, v138
    v_exp_f32 v139, v139
    v_cvt_pk_bf16_f32 v167, v136, v137
    v_exp_f32 v140, v140
    v_mfma_f32_32x32x16_bf16 v[86:101], v[50:53], v[174:177], v[86:101]
    s_add_u32 m0, s29, 1024
    v_exp_f32 v141, v141
    v_cvt_pk_bf16_f32 v168, v138, v139
    v_exp_f32 v142, v142
    v_exp_f32 v143, v143
    v_mfma_f32_32x32x16_bf16 v[86:101], v[54:57], v[178:181], v[86:101]
    ds_read_b128 v[50:53], v4 offset:30720
    ds_read_b128 v[54:57], v4 offset:31744
    buffer_load_dwordx4 v193, s[8:11], s24 offen lds
    v_cvt_pk_bf16_f32 v169, v140, v141
    v_exp_f32 v144, v144
    v_exp_f32 v145, v145
    v_cvt_pk_bf16_f32 v170, v142, v143
    v_mfma_f32_16x16x32_bf16 v[66:69], v[58:61], v[174:177], v[66:69]
    s_add_u32 m0, s29, 2048
    v_exp_f32 v146, v146
    v_exp_f32 v147, v147
    v_cvt_pk_bf16_f32 v171, v144, v145
    v_mfma_f32_16x16x32_bf16 v[66:69], v[58:61], v[178:181], v[66:69]
    buffer_load_dwordx4 v194, s[8:11], s24 offen lds
    v_exp_f32 v148, v148
    v_exp_f32 v149, v149
    v_cvt_pk_bf16_f32 v172, v146, v147
    s_waitcnt lgkmcnt(4)
    v_cvt_pk_bf16_f32 v173, v148, v149
    v_mfma_f32_32x32x16_bf16 v[134:149], v[34:37], v[10:13], v[102:117]
    s_add_u32 m0, s29, 3072
    v_exp_f32 v150, v150
    v_exp_f32 v151, v151
    v_exp_f32 v152, v152
    v_exp_f32 v153, v153
    v_cvt_pk_bf16_f32 v174, v150, v151
    v_mfma_f32_32x32x16_bf16 v[134:149], v[38:41], v[14:17], v[134:149]
    buffer_load_dwordx4 v195, s[8:11], s24 offen lds
    v_exp_f32 v154, v154
    v_exp_f32 v155, v155
    v_cvt_pk_bf16_f32 v175, v152, v153
    v_exp_f32 v156, v156
    v_mfma_f32_32x32x16_bf16 v[70:85], v[42:45], v[166:169], v[70:85]
    v_exp_f32 v157, v157
    v_cvt_pk_bf16_f32 v176, v154, v155
    v_exp_f32 v158, v158
    v_exp_f32 v159, v159
    v_mfma_f32_32x32x16_bf16 v[70:85], v[46:49], v[170:173], v[70:85]
    v_cvt_pk_bf16_f32 v177, v156, v157
    v_exp_f32 v160, v160
    v_exp_f32 v161, v161
    v_cvt_pk_bf16_f32 v178, v158, v159
    v_mfma_f32_16x16x32_bf16 v[62:65], v[58:61], v[166:169], v[62:65]
    v_exp_f32 v162, v162
    v_exp_f32 v163, v163
    v_cvt_pk_bf16_f32 v179, v160, v161
    v_mfma_f32_16x16x32_bf16 v[62:65], v[58:61], v[170:173], v[62:65]
    v_exp_f32 v164, v164
    v_exp_f32 v165, v165
    v_cvt_pk_bf16_f32 v180, v162, v163
    v_cvt_pk_bf16_f32 v181, v164, v165
    v_mfma_f32_32x32x16_bf16 v[150:165], v[34:37], v[18:21], v[118:133]
    s_add_u32 m0, s29, 16384
    v_exp_f32 v134, v134
    v_exp_f32 v135, v135
    v_exp_f32 v136, v136
    v_exp_f32 v137, v137
    v_cvt_pk_bf16_f32 v166, v134, v135
    v_mfma_f32_32x32x16_bf16 v[150:165], v[38:41], v[22:25], v[150:165]
    ds_read_b128 v[34:37], v5 offset:2048
    ds_read_b128 v[38:41], v5 offset:3072
    buffer_load_dwordx4 v192, s[12:15], s24 offen lds
    v_exp_f32 v138, v138
    v_exp_f32 v139, v139
    v_cvt_pk_bf16_f32 v167, v136, v137
    v_exp_f32 v140, v140
    v_mfma_f32_32x32x16_bf16 v[86:101], v[42:45], v[174:177], v[86:101]
    s_add_u32 m0, s29, 17408
    v_exp_f32 v141, v141
    v_cvt_pk_bf16_f32 v168, v138, v139
    v_exp_f32 v142, v142
    v_exp_f32 v143, v143
    v_mfma_f32_32x32x16_bf16 v[86:101], v[46:49], v[178:181], v[86:101]
    ds_read_b128 v[42:45], v5 offset:16384
    ds_read_b128 v[46:49], v5 offset:17408
    buffer_load_dwordx4 v193, s[12:15], s24 offen lds
    v_cvt_pk_bf16_f32 v169, v140, v141
    v_exp_f32 v144, v144
    v_exp_f32 v145, v145
    v_cvt_pk_bf16_f32 v170, v142, v143
    v_mfma_f32_16x16x32_bf16 v[66:69], v[58:61], v[174:177], v[66:69]
    s_add_u32 m0, s29, 18432
    v_exp_f32 v146, v146
    v_exp_f32 v147, v147
    v_cvt_pk_bf16_f32 v171, v144, v145
    v_mfma_f32_16x16x32_bf16 v[66:69], v[58:61], v[178:181], v[66:69]
    buffer_load_dwordx4 v194, s[12:15], s24 offen lds
    v_exp_f32 v148, v148
    v_exp_f32 v149, v149
    v_cvt_pk_bf16_f32 v172, v146, v147
    s_waitcnt lgkmcnt(4)
    v_cvt_pk_bf16_f32 v173, v148, v149
    v_mfma_f32_32x32x16_bf16 v[134:149], v[26:29], v[10:13], v[102:117]
    s_add_u32 m0, s29, 19456
    v_exp_f32 v150, v150
    v_exp_f32 v151, v151
    v_exp_f32 v152, v152
    v_exp_f32 v153, v153
    v_cvt_pk_bf16_f32 v174, v150, v151
    v_mfma_f32_32x32x16_bf16 v[134:149], v[30:33], v[14:17], v[134:149]
    buffer_load_dwordx4 v195, s[12:15], s24 offen lds
    v_exp_f32 v154, v154
    v_exp_f32 v155, v155
    v_cvt_pk_bf16_f32 v175, v152, v153
    v_exp_f32 v156, v156
    v_mfma_f32_32x32x16_bf16 v[70:85], v[50:53], v[166:169], v[70:85]
    v_exp_f32 v157, v157
    v_cvt_pk_bf16_f32 v176, v154, v155
    v_exp_f32 v158, v158
    v_exp_f32 v159, v159
    v_mfma_f32_32x32x16_bf16 v[70:85], v[54:57], v[170:173], v[70:85]
    v_cvt_pk_bf16_f32 v177, v156, v157
    v_exp_f32 v160, v160
    v_exp_f32 v161, v161
    v_cvt_pk_bf16_f32 v178, v158, v159
    v_mfma_f32_16x16x32_bf16 v[62:65], v[58:61], v[166:169], v[62:65]
    v_exp_f32 v162, v162
    v_exp_f32 v163, v163
    v_cvt_pk_bf16_f32 v179, v160, v161
    v_mfma_f32_16x16x32_bf16 v[62:65], v[58:61], v[170:173], v[62:65]
    s_add_u32 s24, s24, 16384
    s_cmp_lt_u32 s47, 458752
    s_cselect_b32 m0, s39, s48
    s_add_u32 s39, s39, 1024
    buffer_load_dwordx4 v190, s[40:43], s47 offen lds
    s_add_u32 s47, s47, 57344
    s_mov_b32 m0, s48
    s_nop 0
    buffer_load_dwordx4 v191, s[52:55], s49 offen lds
    s_add_u32 s49, s49, 1024
    v_exp_f32 v164, v164
    v_exp_f32 v165, v165
    v_cvt_pk_bf16_f32 v180, v162, v163
    v_cvt_pk_bf16_f32 v181, v164, v165
    s_mov_b32 s25, s31
    v_mov_b32 v4, v5
    s_sub_u32 s27, s27, 1
    s_cmp_lg_u32 s27, 0
    s_cbranch_scc1 LOOP_21
    s_nop 1
    v_mfma_f32_32x32x16_bf16 v[86:101], v[50:53], v[174:177], v[86:101]
    v_mfma_f32_32x32x16_bf16 v[86:101], v[54:57], v[178:181], v[86:101]
    v_mfma_f32_16x16x32_bf16 v[66:69], v[58:61], v[174:177], v[66:69]
    v_mfma_f32_16x16x32_bf16 v[66:69], v[58:61], v[178:181], v[66:69]
    s_lshl_b32 s16, s23, 16
    s_lshl_b32 s17, s20, 11
    s_add_u32 s16, s16, s17
    s_add_u32 s16, s4, s16
    s_addc_u32 s17, s5, 0
    s_add_u32 s16, s16, 22020096
    s_addc_u32 s17, s17, 0
    s_and_b32 s17, s17, 0xffff
    s_mov_b32 s18, 67584
    s_mov_b32 s19, 0x20000
    s_mov_b32 s29, 65536
    v_rcp_f32 v182, v62
    s_nop 0
    v_mul_f32 v70, v70, v182
    v_mul_f32 v71, v71, v182
    v_mul_f32 v72, v72, v182
    v_mul_f32 v73, v73, v182
    v_mul_f32 v74, v74, v182
    v_mul_f32 v75, v75, v182
    v_mul_f32 v76, v76, v182
    v_mul_f32 v77, v77, v182
    v_mul_f32 v78, v78, v182
    v_mul_f32 v79, v79, v182
    v_mul_f32 v80, v80, v182
    v_mul_f32 v81, v81, v182
    v_mul_f32 v82, v82, v182
    v_mul_f32 v83, v83, v182
    v_mul_f32 v84, v84, v182
    v_mul_f32 v85, v85, v182
    v_cvt_pk_bf16_f32 v166, v70, v71
    v_cvt_pk_bf16_f32 v167, v72, v73
    v_cvt_pk_bf16_f32 v168, v74, v75
    v_cvt_pk_bf16_f32 v169, v76, v77
    v_cvt_pk_bf16_f32 v170, v78, v79
    v_cvt_pk_bf16_f32 v171, v80, v81
    v_cvt_pk_bf16_f32 v172, v82, v83
    v_cvt_pk_bf16_f32 v173, v84, v85
    buffer_store_dwordx4 v[166:169], v2, s[16:19], 0 offen sc1
    buffer_store_dwordx4 v[170:173], v2, s[16:19], 0 offen offset:1024 sc1
    v_rcp_f32 v183, v66
    s_nop 0
    v_mul_f32 v86, v86, v183
    v_mul_f32 v87, v87, v183
    v_mul_f32 v88, v88, v183
    v_mul_f32 v89, v89, v183
    v_mul_f32 v90, v90, v183
    v_mul_f32 v91, v91, v183
    v_mul_f32 v92, v92, v183
    v_mul_f32 v93, v93, v183
    v_mul_f32 v94, v94, v183
    v_mul_f32 v95, v95, v183
    v_mul_f32 v96, v96, v183
    v_mul_f32 v97, v97, v183
    v_mul_f32 v98, v98, v183
    v_mul_f32 v99, v99, v183
    v_mul_f32 v100, v100, v183
    v_mul_f32 v101, v101, v183
    v_cvt_pk_bf16_f32 v174, v86, v87
    v_cvt_pk_bf16_f32 v175, v88, v89
    v_cvt_pk_bf16_f32 v176, v90, v91
    v_cvt_pk_bf16_f32 v177, v92, v93
    v_cvt_pk_bf16_f32 v178, v94, v95
    v_cvt_pk_bf16_f32 v179, v96, v97
    v_cvt_pk_bf16_f32 v180, v98, v99
    v_cvt_pk_bf16_f32 v181, v100, v101
    buffer_store_dwordx4 v[174:177], v2, s[16:19], s29 offen sc1
    buffer_store_dwordx4 v[178:181], v2, s[16:19], s29 offen offset:1024 sc1
    s_cmp_lg_u32 s28, 0
    s_cbranch_scc1 DONE_23
    v_mul_f32 v184, 0, v62
    v_mul_f32 v185, 0, v66
    v_pk_fma_f32 v[184:185], v[70:71], 0, v[184:185]
    v_pk_fma_f32 v[184:185], v[72:73], 0, v[184:185]
    v_pk_fma_f32 v[184:185], v[74:75], 0, v[184:185]
    v_pk_fma_f32 v[184:185], v[76:77], 0, v[184:185]
    v_pk_fma_f32 v[184:185], v[78:79], 0, v[184:185]
    v_pk_fma_f32 v[184:185], v[80:81], 0, v[184:185]
    v_pk_fma_f32 v[184:185], v[82:83], 0, v[184:185]
    v_pk_fma_f32 v[184:185], v[84:85], 0, v[184:185]
    v_pk_fma_f32 v[184:185], v[86:87], 0, v[184:185]
    v_pk_fma_f32 v[184:185], v[88:89], 0, v[184:185]
    v_pk_fma_f32 v[184:185], v[90:91], 0, v[184:185]
    v_pk_fma_f32 v[184:185], v[92:93], 0, v[184:185]
    v_pk_fma_f32 v[184:185], v[94:95], 0, v[184:185]
    v_pk_fma_f32 v[184:185], v[96:97], 0, v[184:185]
    v_pk_fma_f32 v[184:185], v[98:99], 0, v[184:185]
    v_pk_fma_f32 v[184:185], v[100:101], 0, v[184:185]
    v_add_f32 v184, v184, v185
    v_mov_b32 v6, 3072
    v_cmp_u_f32 vcc, v184, v184
    v_mov_b32 v7, 1
    s_nop 1
    s_and_saveexec_b64 s[30:31], vcc
    ds_write_b32 v6, v7
    s_mov_b64 exec, s[30:31]
    s_waitcnt lgkmcnt(0)
    s_barrier
    ds_read_b32 v7, v6
    s_waitcnt lgkmcnt(0)
    v_readfirstlane_b32 s29, v7
    s_nop 3
    s_cmp_eq_u32 s29, 0
    s_cbranch_scc1 DONE_23
    s_mov_b32 s28, 1
    s_mov_b32 s24, s26
    s_mov_b32 s27, 8
    v_mov_b32 v182, 0xff800000
    v_mov_b32 v183, 0xff800000
    s_waitcnt vmcnt(0)
FBL_22:
    s_barrier
    s_add_u32 m0, s33, 0
    s_nop 0
    buffer_load_dwordx4 v192, s[8:11], s24 offen lds
    s_add_u32 m0, s33, 1024
    s_nop 0
    buffer_load_dwordx4 v193, s[8:11], s24 offen lds
    s_add_u32 m0, s33, 2048
    s_nop 0
    buffer_load_dwordx4 v194, s[8:11], s24 offen lds
    s_add_u32 m0, s33, 3072
    s_nop 0
    buffer_load_dwordx4 v195, s[8:11], s24 offen lds
    s_waitcnt vmcnt(0)
    s_barrier
    ds_read_b128 v[26:29], v3 offset:0
    ds_read_b128 v[30:33], v3 offset:1024
    s_waitcnt lgkmcnt(0)
    v_mfma_f32_32x32x16_bf16 v[134:149], v[26:29], v[10:13], 0
    v_mfma_f32_32x32x16_bf16 v[134:149], v[30:33], v[14:17], v[134:149]
    v_mfma_f32_32x32x16_bf16 v[150:165], v[26:29], v[18:21], 0
    v_mfma_f32_32x32x16_bf16 v[150:165], v[30:33], v[22:25], v[150:165]
    s_nop 15
    v_max3_f32 v182, v182, v134, v135
    v_max3_f32 v182, v182, v136, v137
    v_max3_f32 v182, v182, v138, v139
    v_max3_f32 v182, v182, v140, v141
    v_max3_f32 v182, v182, v142, v143
    v_max3_f32 v182, v182, v144, v145
    v_max3_f32 v182, v182, v146, v147
    v_max3_f32 v182, v182, v148, v149
    v_max3_f32 v183, v183, v150, v151
    v_max3_f32 v183, v183, v152, v153
    v_max3_f32 v183, v183, v154, v155
    v_max3_f32 v183, v183, v156, v157
    v_max3_f32 v183, v183, v158, v159
    v_max3_f32 v183, v183, v160, v161
    v_max3_f32 v183, v183, v162, v163
    v_max3_f32 v183, v183, v164, v165
    ds_read_b128 v[26:29], v3 offset:2048
    ds_read_b128 v[30:33], v3 offset:3072
    s_waitcnt lgkmcnt(0)
    v_mfma_f32_32x32x16_bf16 v[134:149], v[26:29], v[10:13], 0
    v_mfma_f32_32x32x16_bf16 v[134:149], v[30:33], v[14:17], v[134:149]
    v_mfma_f32_32x32x16_bf16 v[150:165], v[26:29], v[18:21], 0
    v_mfma_f32_32x32x16_bf16 v[150:165], v[30:33], v[22:25], v[150:165]
    s_nop 15
    v_max3_f32 v182, v182, v134, v135
    v_max3_f32 v182, v182, v136, v137
    v_max3_f32 v182, v182, v138, v139
    v_max3_f32 v182, v182, v140, v141
    v_max3_f32 v182, v182, v142, v143
    v_max3_f32 v182, v182, v144, v145
    v_max3_f32 v182, v182, v146, v147
    v_max3_f32 v182, v182, v148, v149
    v_max3_f32 v183, v183, v150, v151
    v_max3_f32 v183, v183, v152, v153
    v_max3_f32 v183, v183, v154, v155
    v_max3_f32 v183, v183, v156, v157
    v_max3_f32 v183, v183, v158, v159
    v_max3_f32 v183, v183, v160, v161
    v_max3_f32 v183, v183, v162, v163
    v_max3_f32 v183, v183, v164, v165
    ds_read_b128 v[26:29], v3 offset:4096
    ds_read_b128 v[30:33], v3 offset:5120
    s_waitcnt lgkmcnt(0)
    v_mfma_f32_32x32x16_bf16 v[134:149], v[26:29], v[10:13], 0
    v_mfma_f32_32x32x16_bf16 v[134:149], v[30:33], v[14:17], v[134:149]
    v_mfma_f32_32x32x16_bf16 v[150:165], v[26:29], v[18:21], 0
    v_mfma_f32_32x32x16_bf16 v[150:165], v[30:33], v[22:25], v[150:165]
    s_nop 15
    v_max3_f32 v182, v182, v134, v135
    v_max3_f32 v182, v182, v136, v137
    v_max3_f32 v182, v182, v138, v139
    v_max3_f32 v182, v182, v140, v141
    v_max3_f32 v182, v182, v142, v143
    v_max3_f32 v182, v182, v144, v145
    v_max3_f32 v182, v182, v146, v147
    v_max3_f32 v182, v182, v148, v149
    v_max3_f32 v183, v183, v150, v151
    v_max3_f32 v183, v183, v152, v153
    v_max3_f32 v183, v183, v154, v155
    v_max3_f32 v183, v183, v156, v157
    v_max3_f32 v183, v183, v158, v159
    v_max3_f32 v183, v183, v160, v161
    v_max3_f32 v183, v183, v162, v163
    v_max3_f32 v183, v183, v164, v165
    ds_read_b128 v[26:29], v3 offset:6144
    ds_read_b128 v[30:33], v3 offset:7168
    s_waitcnt lgkmcnt(0)
    v_mfma_f32_32x32x16_bf16 v[134:149], v[26:29], v[10:13], 0
    v_mfma_f32_32x32x16_bf16 v[134:149], v[30:33], v[14:17], v[134:149]
    v_mfma_f32_32x32x16_bf16 v[150:165], v[26:29], v[18:21], 0
    v_mfma_f32_32x32x16_bf16 v[150:165], v[30:33], v[22:25], v[150:165]
    s_nop 15
    v_max3_f32 v182, v182, v134, v135
    v_max3_f32 v182, v182, v136, v137
    v_max3_f32 v182, v182, v138, v139
    v_max3_f32 v182, v182, v140, v141
    v_max3_f32 v182, v182, v142, v143
    v_max3_f32 v182, v182, v144, v145
    v_max3_f32 v182, v182, v146, v147
    v_max3_f32 v182, v182, v148, v149
    v_max3_f32 v183, v183, v150, v151
    v_max3_f32 v183, v183, v152, v153
    v_max3_f32 v183, v183, v154, v155
    v_max3_f32 v183, v183, v156, v157
    v_max3_f32 v183, v183, v158, v159
    v_max3_f32 v183, v183, v160, v161
    v_max3_f32 v183, v183, v162, v163
    v_max3_f32 v183, v183, v164, v165
    ds_read_b128 v[26:29], v3 offset:8192
    ds_read_b128 v[30:33], v3 offset:9216
    s_waitcnt lgkmcnt(0)
    v_mfma_f32_32x32x16_bf16 v[134:149], v[26:29], v[10:13], 0
    v_mfma_f32_32x32x16_bf16 v[134:149], v[30:33], v[14:17], v[134:149]
    v_mfma_f32_32x32x16_bf16 v[150:165], v[26:29], v[18:21], 0
    v_mfma_f32_32x32x16_bf16 v[150:165], v[30:33], v[22:25], v[150:165]
    s_nop 15
    v_max3_f32 v182, v182, v134, v135
    v_max3_f32 v182, v182, v136, v137
    v_max3_f32 v182, v182, v138, v139
    v_max3_f32 v182, v182, v140, v141
    v_max3_f32 v182, v182, v142, v143
    v_max3_f32 v182, v182, v144, v145
    v_max3_f32 v182, v182, v146, v147
    v_max3_f32 v182, v182, v148, v149
    v_max3_f32 v183, v183, v150, v151
    v_max3_f32 v183, v183, v152, v153
    v_max3_f32 v183, v183, v154, v155
    v_max3_f32 v183, v183, v156, v157
    v_max3_f32 v183, v183, v158, v159
    v_max3_f32 v183, v183, v160, v161
    v_max3_f32 v183, v183, v162, v163
    v_max3_f32 v183, v183, v164, v165
    ds_read_b128 v[26:29], v3 offset:10240
    ds_read_b128 v[30:33], v3 offset:11264
    s_waitcnt lgkmcnt(0)
    v_mfma_f32_32x32x16_bf16 v[134:149], v[26:29], v[10:13], 0
    v_mfma_f32_32x32x16_bf16 v[134:149], v[30:33], v[14:17], v[134:149]
    v_mfma_f32_32x32x16_bf16 v[150:165], v[26:29], v[18:21], 0
    v_mfma_f32_32x32x16_bf16 v[150:165], v[30:33], v[22:25], v[150:165]
    s_nop 15
    v_max3_f32 v182, v182, v134, v135
    v_max3_f32 v182, v182, v136, v137
    v_max3_f32 v182, v182, v138, v139
    v_max3_f32 v182, v182, v140, v141
    v_max3_f32 v182, v182, v142, v143
    v_max3_f32 v182, v182, v144, v145
    v_max3_f32 v182, v182, v146, v147
    v_max3_f32 v182, v182, v148, v149
    v_max3_f32 v183, v183, v150, v151
    v_max3_f32 v183, v183, v152, v153
    v_max3_f32 v183, v183, v154, v155
    v_max3_f32 v183, v183, v156, v157
    v_max3_f32 v183, v183, v158, v159
    v_max3_f32 v183, v183, v160, v161
    v_max3_f32 v183, v183, v162, v163
    v_max3_f32 v183, v183, v164, v165
    ds_read_b128 v[26:29], v3 offset:12288
    ds_read_b128 v[30:33], v3 offset:13312
    s_waitcnt lgkmcnt(0)
    v_mfma_f32_32x32x16_bf16 v[134:149], v[26:29], v[10:13], 0
    v_mfma_f32_32x32x16_bf16 v[134:149], v[30:33], v[14:17], v[134:149]
    v_mfma_f32_32x32x16_bf16 v[150:165], v[26:29], v[18:21], 0
    v_mfma_f32_32x32x16_bf16 v[150:165], v[30:33], v[22:25], v[150:165]
    s_nop 15
    v_max3_f32 v182, v182, v134, v135
    v_max3_f32 v182, v182, v136, v137
    v_max3_f32 v182, v182, v138, v139
    v_max3_f32 v182, v182, v140, v141
    v_max3_f32 v182, v182, v142, v143
    v_max3_f32 v182, v182, v144, v145
    v_max3_f32 v182, v182, v146, v147
    v_max3_f32 v182, v182, v148, v149
    v_max3_f32 v183, v183, v150, v151
    v_max3_f32 v183, v183, v152, v153
    v_max3_f32 v183, v183, v154, v155
    v_max3_f32 v183, v183, v156, v157
    v_max3_f32 v183, v183, v158, v159
    v_max3_f32 v183, v183, v160, v161
    v_max3_f32 v183, v183, v162, v163
    v_max3_f32 v183, v183, v164, v165
    ds_read_b128 v[26:29], v3 offset:14336
    ds_read_b128 v[30:33], v3 offset:15360
    s_waitcnt lgkmcnt(0)
    v_mfma_f32_32x32x16_bf16 v[134:149], v[26:29], v[10:13], 0
    v_mfma_f32_32x32x16_bf16 v[134:149], v[30:33], v[14:17], v[134:149]
    v_mfma_f32_32x32x16_bf16 v[150:165], v[26:29], v[18:21], 0
    v_mfma_f32_32x32x16_bf16 v[150:165], v[30:33], v[22:25], v[150:165]
    s_nop 15
    v_max3_f32 v182, v182, v134, v135
    v_max3_f32 v182, v182, v136, v137
    v_max3_f32 v182, v182, v138, v139
    v_max3_f32 v182, v182, v140, v141
    v_max3_f32 v182, v182, v142, v143
    v_max3_f32 v182, v182, v144, v145
    v_max3_f32 v182, v182, v146, v147
    v_max3_f32 v182, v182, v148, v149
    v_max3_f32 v183, v183, v150, v151
    v_max3_f32 v183, v183, v152, v153
    v_max3_f32 v183, v183, v154, v155
    v_max3_f32 v183, v183, v156, v157
    v_max3_f32 v183, v183, v158, v159
    v_max3_f32 v183, v183, v160, v161
    v_max3_f32 v183, v183, v162, v163
    v_max3_f32 v183, v183, v164, v165
    s_add_u32 s24, s24, 16384
    s_sub_u32 s27, s27, 1
    s_cmp_lg_u32 s27, 0
    s_cbranch_scc1 FBL_22
    s_barrier
    s_mov_b32 s24, s26
    s_add_u32 m0, s33, 0
    s_nop 0
    buffer_load_dwordx4 v192, s[8:11], s24 offen lds
    s_add_u32 m0, s33, 1024
    s_nop 0
    buffer_load_dwordx4 v193, s[8:11], s24 offen lds
    s_add_u32 m0, s33, 2048
    s_nop 0
    buffer_load_dwordx4 v194, s[8:11], s24 offen lds
    s_add_u32 m0, s33, 3072
    s_nop 0
    buffer_load_dwordx4 v195, s[8:11], s24 offen lds
    s_add_u32 m0, s33, 16384
    s_nop 0
    buffer_load_dwordx4 v192, s[12:15], s24 offen lds
    s_add_u32 m0, s33, 17408
    s_nop 0
    buffer_load_dwordx4 v193, s[12:15], s24 offen lds
    s_add_u32 m0, s33, 18432
    s_nop 0
    buffer_load_dwordx4 v194, s[12:15], s24 offen lds
    s_add_u32 m0, s33, 19456
    s_nop 0
    buffer_load_dwordx4 v195, s[12:15], s24 offen lds
    s_add_u32 s24, s24, 16384
    v_mov_b32 v70, 0
    v_mov_b32 v71, 0
    v_mov_b32 v72, 0
    v_mov_b32 v73, 0
    v_mov_b32 v74, 0
    v_mov_b32 v75, 0
    v_mov_b32 v76, 0
    v_mov_b32 v77, 0
    v_mov_b32 v78, 0
    v_mov_b32 v79, 0
    v_mov_b32 v80, 0
    v_mov_b32 v81, 0
    v_mov_b32 v82, 0
    v_mov_b32 v83, 0
    v_mov_b32 v84, 0
    v_mov_b32 v85, 0
    v_mov_b32 v86, 0
    v_mov_b32 v87, 0
    v_mov_b32 v88, 0
    v_mov_b32 v89, 0
    v_mov_b32 v90, 0
    v_mov_b32 v91, 0
    v_mov_b32 v92, 0
    v_mov_b32 v93, 0
    v_mov_b32 v94, 0
    v_mov_b32 v95, 0
    v_mov_b32 v96, 0
    v_mov_b32 v97, 0
    v_mov_b32 v98, 0
    v_mov_b32 v99, 0
    v_mov_b32 v100, 0
    v_mov_b32 v101, 0
    v_mov_b32 v62, 0
    v_mov_b32 v63, 0
    v_mov_b32 v64, 0
    v_mov_b32 v65, 0
    v_mov_b32 v66, 0
    v_mov_b32 v67, 0
    v_mov_b32 v68, 0
    v_mov_b32 v69, 0
    v_mov_b32 v174, 0
    v_mov_b32 v175, 0
    v_mov_b32 v176, 0
    v_mov_b32 v177, 0
    v_mov_b32 v178, 0
    v_mov_b32 v179, 0
    v_mov_b32 v180, 0
    v_mov_b32 v181, 0
    v_mov_b32 v50, 0
    v_mov_b32 v51, 0
    v_mov_b32 v52, 0
    v_mov_b32 v53, 0
    v_mov_b32 v54, 0
    v_mov_b32 v55, 0
    v_mov_b32 v56, 0
    v_mov_b32 v57, 0
    s_waitcnt vmcnt(0)
    s_barrier
    ds_read_b128 v[26:29], v3 offset:0
    ds_read_b128 v[30:33], v3 offset:1024
    ds_read_b128 v[34:37], v3 offset:2048
    ds_read_b128 v[38:41], v3 offset:3072
    ds_read_b128 v[42:45], v3 offset:16384
    ds_read_b128 v[46:49], v3 offset:17408
    s_add_u32 m0, s33, 32768
    s_nop 0
    buffer_load_dwordx4 v192, s[8:11], s24 offen lds
    s_add_u32 m0, s33, 33792
    s_nop 0
    buffer_load_dwordx4 v193, s[8:11], s24 offen lds
    s_add_u32 m0, s33, 34816
    s_nop 0
    buffer_load_dwordx4 v194, s[8:11], s24 offen lds
    s_add_u32 m0, s33, 35840
    s_nop 0
    buffer_load_dwordx4 v195, s[8:11], s24 offen lds
    s_add_u32 m0, s33, 49152
    s_nop 0
    buffer_load_dwordx4 v192, s[12:15], s24 offen lds
    s_add_u32 m0, s33, 50176
    s_nop 0
    buffer_load_dwordx4 v193, s[12:15], s24 offen lds
    s_add_u32 m0, s33, 51200
    s_nop 0
    buffer_load_dwordx4 v194, s[12:15], s24 offen lds
    s_add_u32 m0, s33, 52224
    s_nop 0
    buffer_load_dwordx4 v195, s[12:15], s24 offen lds
    s_add_u32 s24, s24, 16384
    s_cmp_lt_u32 s47, 458752
    s_cselect_b32 m0, s39, s48
    s_add_u32 s39, s39, 1024
    buffer_load_dwordx4 v190, s[40:43], s47 offen lds
    s_add_u32 s47, s47, 57344
    s_mov_b32 m0, s48
    s_nop 0
    buffer_load_dwordx4 v191, s[52:55], s49 offen lds
    s_add_u32 s49, s49, 1024
    s_branch GO_25
DONE_23:
    s_waitcnt lgkmcnt(0)
    s_mov_b64 exec, -1
    s_waitcnt vmcnt(0)
    s_barrier
    s_cmp_lg_u32 s22, 0
    s_cbranch_scc1 NOSIG_28
    s_add_u32 s84, s4, 720896
    s_addc_u32 s85, s5, 0
    s_and_b32 s85, s85, 0xffff
    s_mov_b32 s86, 131072
    s_mov_b32 s87, 0x20000
    s_lshl_b32 s88, s21, 7
    s_add_u32 s88, s88, 24576
    s_lshl_b32 s89, s20, 2
    s_add_u32 s88, s88, s89
    s_mov_b64 exec, 1
    v_mov_b32 v254, 1
    v_mov_b32 v255, s88
    buffer_store_dword v254, v255, s[84:87], 0 offen sc1
    s_mov_b64 exec, -1
NOSIG_28:
    s_lshl_b32 s50, s22, 12
    s_add_u32 s50, s50, 4096
    s_mov_b32 s51, 0
    s_add_u32 m0, s50, 0
    s_nop 0
    buffer_load_dwordx4 v208, s[56:59], s51 offen lds
    s_add_u32 m0, s50, 1024
    s_nop 0
    buffer_load_dwordx4 v209, s[56:59], s51 offen lds
    s_add_u32 m0, s50, 2048
    s_nop 0
    buffer_load_dwordx4 v210, s[56:59], s51 offen lds
    s_add_u32 m0, s50, 3072
    s_nop 0
    buffer_load_dwordx4 v211, s[56:59], s51 offen lds
    s_mov_b32 s51, 262144
    s_add_u32 m0, s50, 16384
    s_nop 0
    buffer_load_dwordx4 v208, s[56:59], s51 offen lds
    s_add_u32 m0, s50, 17408
    s_nop 0
    buffer_load_dwordx4 v209, s[56:59], s51 offen lds
    s_add_u32 m0, s50, 18432
    s_nop 0
    buffer_load_dwordx4 v210, s[56:59], s51 offen lds
    s_add_u32 m0, s50, 19456
    s_nop 0
    buffer_load_dwordx4 v211, s[56:59], s51 offen lds
    s_mov_b32 s51, 524288
    s_add_u32 m0, s50, 32768
    s_nop 0
    buffer_load_dwordx4 v208, s[56:59], s51 offen lds
    s_add_u32 m0, s50, 33792
    s_nop 0
    buffer_load_dwordx4 v209, s[56:59], s51 offen lds
    s_add_u32 m0, s50, 34816
    s_nop 0
    buffer_load_dwordx4 v210, s[56:59], s51 offen lds
    s_add_u32 m0, s50, 35840
    s_nop 0
    buffer_load_dwordx4 v211, s[56:59], s51 offen lds
    s_mov_b32 s51, 786432
    s_add_u32 m0, s50, 49152
    s_nop 0
    buffer_load_dwordx4 v208, s[56:59], s51 offen lds
    s_add_u32 m0, s50, 50176
    s_nop 0
    buffer_load_dwordx4 v209, s[56:59], s51 offen lds
    s_add_u32 m0, s50, 51200
    s_nop 0
    buffer_load_dwordx4 v210, s[56:59], s51 offen lds
    s_add_u32 m0, s50, 52224
    s_nop 0
    buffer_load_dwordx4 v211, s[56:59], s51 offen lds
    s_mov_b32 s51, 1048576
    s_add_u32 m0, s50, 65536
    s_nop 0
    buffer_load_dwordx4 v208, s[56:59], s51 offen lds
    s_add_u32 m0, s50, 66560
    s_nop 0
    buffer_load_dwordx4 v209, s[56:59], s51 offen lds
    s_add_u32 m0, s50, 67584
    s_nop 0
    buffer_load_dwordx4 v210, s[56:59], s51 offen lds
    s_add_u32 m0, s50, 68608
    s_nop 0
    buffer_load_dwordx4 v211, s[56:59], s51 offen lds
    s_mov_b32 s51, 1310720
    s_add_u32 m0, s50, 81920
    s_nop 0
    buffer_load_dwordx4 v208, s[56:59], s51 offen lds
    s_add_u32 m0, s50, 82944
    s_nop 0
    buffer_load_dwordx4 v209, s[56:59], s51 offen lds
    s_add_u32 m0, s50, 83968
    s_nop 0
    buffer_load_dwordx4 v210, s[56:59], s51 offen lds
    s_add_u32 m0, s50, 84992
    s_nop 0
    buffer_load_dwordx4 v211, s[56:59], s51 offen lds
    s_cmp_ge_u32 s2, 224
    s_cbranch_scc1 NOUW_24
    s_nop 0
    v_cvt_pk_bf16_f32 v182, v196, v197
    v_lshlrev_b32 v6, 1, v0
    ds_write_b16 v6, v182 offset:0
    ds_write_b16_d16_hi v6, v182 offset:512
    v_lshrrev_b32 v6, 5, v1
    v_lshlrev_b32 v6, 2, v6
    v_bfe_u32 v7, v1, 2, 2
    v_add_u32 v6, v6, v7
    v_lshlrev_b32 v6, 7, v6
    v_bfe_u32 v7, v1, 4, 1
    v_lshlrev_b32 v7, 1, v7
    v_bfe_u32 v8, v1, 1, 1
    v_add_u32 v7, v7, v8
    v_bfe_u32 v8, v1, 3, 1
    v_lshlrev_b32 v8, 2, v8
    v_xor_b32 v7, v7, v8
    v_lshlrev_b32 v7, 4, v7
    v_add_u32 v6, v6, v7
    v_and_b32 v8, 1, v1
    v_lshlrev_b32 v8, 3, v8
    v_add_u32 v102, v6, v8
    v_xor_b32 v103, 64, v102
    s_lshl_b32 s16, s22, 13
    s_add_u32 s16, s16, 106496
    v_add_u32 v102, s16, v102
    v_add_u32 v103, s16, v103
    v_lshrrev_b32 v104, 5, v1
    v_lshlrev_b32 v104, 3, v104
    v_and_b32 v105, 1, v1
    v_lshlrev_b32 v105, 9, v105
    v_add_u32 v104, v104, v105
    s_lshl_b32 s16, s22, 7
    s_add_u32 s16, s16, 0
    v_add_u32 v104, s16, v104
    ds_read_b64_tr_b16 v[134:135], v102 offset:0
    ds_read_b64_tr_b16 v[136:137], v102 offset:1024
    ds_read_b64_tr_b16 v[138:139], v103 offset:0
    ds_read_b64_tr_b16 v[140:141], v103 offset:1024
    ds_read_b64_tr_b16 v[142:143], v102 offset:2048
    ds_read_b64_tr_b16 v[144:145], v102 offset:3072
    ds_read_b64_tr_b16 v[146:147], v103 offset:2048
    ds_read_b64_tr_b16 v[148:149], v103 offset:3072
    ds_read_b64_tr_b16 v[150:151], v102 offset:4096
    ds_read_b64_tr_b16 v[152:153], v102 offset:5120
    ds_read_b64_tr_b16 v[154:155], v103 offset:4096
    ds_read_b64_tr_b16 v[156:157], v103 offset:5120
    ds_read_b64_tr_b16 v[158:159], v102 offset:6144
    ds_read_b64_tr_b16 v[160:161], v102 offset:7168
    ds_read_b64_tr_b16 v[162:163], v103 offset:6144
    ds_read_b64_tr_b16 v[164:165], v103 offset:7168
    s_waitcnt lgkmcnt(0)
    ds_read_b64 v[118:119], v104 offset:0
    ds_read_b64 v[120:121], v104 offset:16
    ds_read_b64 v[122:123], v104 offset:32
    ds_read_b64 v[124:125], v104 offset:48
    ds_read_b64 v[126:127], v104 offset:64
    ds_read_b64 v[128:129], v104 offset:80
    ds_read_b64 v[130:131], v104 offset:96
    ds_read_b64 v[132:133], v104 offset:112
    s_waitcnt lgkmcnt(0)
    v_mfma_f32_32x32x16_bf16 v[70:85], v[134:137], v[118:121], 0
    v_mfma_f32_32x32x16_bf16 v[86:101], v[138:141], v[118:121], 0
    v_mfma_f32_32x32x16_bf16 v[70:85], v[142:145], v[122:125], v[70:85]
    v_mfma_f32_32x32x16_bf16 v[86:101], v[146:149], v[122:125], v[86:101]
    v_mfma_f32_32x32x16_bf16 v[70:85], v[150:153], v[126:129], v[70:85]
    v_mfma_f32_32x32x16_bf16 v[86:101], v[154:157], v[126:129], v[86:101]
    v_mfma_f32_32x32x16_bf16 v[70:85], v[158:161], v[130:133], v[70:85]
    v_mfma_f32_32x32x16_bf16 v[86:101], v[162:165], v[130:133], v[86:101]
    v_and_b32 v6, 31, v1
    v_lshrrev_b32 v7, 5, v1
    v_lshlrev_b32 v7, 4, v7
    v_lshlrev_b32 v8, 8, v6
    v_add_u32 v7, v7, v8
    s_lshl_b32 s16, s22, 9
    s_add_u32 s16, s16, 1024
    v_add_u32 v7, s16, v7
    v_cmp_gt_u32 vcc, 2, v6
    s_nop 5
    s_and_saveexec_b64 s[30:31], vcc
    ds_write_b128 v7, v[70:73] offset:0
    ds_write_b128 v7, v[74:77] offset:32
    ds_write_b128 v7, v[78:81] offset:64
    ds_write_b128 v7, v[82:85] offset:96
    ds_write_b128 v7, v[86:89] offset:128
    ds_write_b128 v7, v[90:93] offset:160
    ds_write_b128 v7, v[94:97] offset:192
    ds_write_b128 v7, v[98:101] offset:224
    s_mov_b64 exec, s[30:31]
    s_waitcnt lgkmcnt(0)
    s_barrier
    v_cmp_gt_u32 vcc, 128, v0
    s_and_saveexec_b64 s[30:31], vcc
    s_cbranch_execz NOUW_24
    v_lshlrev_b32 v6, 2, v0
    ds_read_b32 v182, v6 offset:1024
    ds_read_b32 v183, v6 offset:1536
    ds_read_b32 v184, v6 offset:2048
    ds_read_b32 v185, v6 offset:2560
    v_and_b32 v7, 63, v0
    v_lshlrev_b32 v7, 2, v7
    v_lshrrev_b32 v8, 6, v0
    v_mul_u32_u24 v8, 14336, v8
    s_mul_i32 s16, s44, 28672
    s_lshl_b32 s17, s45, 8
    s_add_u32 s16, s16, s17
    v_add3_u32 v6, v7, v8, s16
    s_add_u32 s16, s4, 65536
    s_addc_u32 s17, s5, 0
    s_and_b32 s17, s17, 0xffff
    s_mov_b32 s18, 114688
    s_mov_b32 s19, 0x20000
    s_waitcnt lgkmcnt(0)
    v_add_f32 v182, v182, v183
    v_add_f32 v184, v184, v185
    v_add_f32 v182, v182, v184
    buffer_store_dword v182, v6, s[16:19], 0 offen sc1
NOUW_24:
    s_mov_b64 exec, -1
    s_lshl_b32 s50, s22, 12
    s_add_u32 s50, s50, 4096
    s_mov_b32 s51, 1572864
    s_add_u32 m0, s50, 98304
    s_nop 0
    buffer_load_dwordx4 v208, s[56:59], s51 offen lds
    s_add_u32 m0, s50, 99328
    s_nop 0
    buffer_load_dwordx4 v209, s[56:59], s51 offen lds
    s_add_u32 m0, s50, 100352
    s_nop 0
    buffer_load_dwordx4 v210, s[56:59], s51 offen lds
    s_add_u32 m0, s50, 101376
    s_nop 0
    buffer_load_dwordx4 v211, s[56:59], s51 offen lds
    s_mov_b32 s51, 1835008
    s_add_u32 m0, s50, 114688
    s_nop 0
    buffer_load_dwordx4 v208, s[56:59], s51 offen lds
    s_add_u32 m0, s50, 115712
    s_nop 0
    buffer_load_dwordx4 v209, s[56:59], s51 offen lds
    s_add_u32 m0, s50, 116736
    s_nop 0
    buffer_load_dwordx4 v210, s[56:59], s51 offen lds
    s_add_u32 m0, s50, 117760
    s_nop 0
    buffer_load_dwordx4 v211, s[56:59], s51 offen lds
    s_cmp_ge_u32 s2, 224
    s_cbranch_scc1 NOUWS_29
    s_lshl_b32 s90, s45, 2
    s_add_u32 s90, s90, s44
    s_mov_b32 s91, 0
    s_mov_b64 exec, -1
    s_waitcnt vmcnt(8)
    s_barrier
    s_cmp_lg_u32 s22, 0
    s_cbranch_scc1 NOSIG_30
    s_add_u32 s84, s4, 720896
    s_addc_u32 s85, s5, 0
    s_and_b32 s85, s85, 0xffff
    s_mov_b32 s86, 131072
    s_mov_b32 s87, 0x20000
    s_lshl_b32 s88, s91, 7
    s_add_u32 s88, s88, 32768
    s_lshl_b32 s89, s90, 2
    s_add_u32 s88, s88, s89
    s_mov_b64 exec, 1
    v_mov_b32 v254, 1
    v_mov_b32 v255, s88
    buffer_store_dword v254, v255, s[84:87], 0 offen sc1
    s_mov_b64 exec, -1
NOSIG_30:
NOUWS_29:
    s_mov_b64 exec, -1
PHW_17:
    s_mov_b64 s[6:7], s[96:97]
    v_lshrrev_b32 v16, 6, v0
    v_and_b32 v1, 63, v0
    v_readfirstlane_b32 s22, v16
    s_and_b32 s16, s2, 7
    s_lshr_b32 s17, s2, 3
    s_lshr_b32 s18, s16, 1
    s_lshl_b32 s18, s18, 2
    s_lshr_b32 s19, s17, 3
    s_add_u32 s20, s18, s19
    s_and_b32 s18, s16, 1
    s_lshl_b32 s18, s18, 3
    s_and_b32 s19, s17, 7
    s_add_u32 s21, s18, s19
    s_lshl_b32 s23, s20, 2
    s_add_u32 s23, s23, s22
    s_mul_i32 s16, s23, 65536
    v_lshlrev_b32 v2, 4, v1
    v_lshrrev_b32 v18, 3, v1
    v_bfe_u32 v19, v1, 4, 1
    v_lshlrev_b32 v19, 2, v19
    v_and_b32 v17, 7, v1
    v_xor_b32 v17, v17, v19
    v_lshlrev_b32 v17, 4, v17
    v_mul_u32_u24 v18, 2048, v18
    v_add_u32 v17, v17, v18
    s_mul_i32 s17, s22, 65536
    s_lshl_b32 s18, s21, 7
    s_add_u32 s17, s17, s18
    v_add_u32 v17, s17, v17
    s_mul_i32 s26, s22, 4096
    v_mov_b32 v8, v17
    v_add_u32 v9, 16384, v17
    v_add_u32 v10, 32768, v17
    v_add_u32 v11, 49152, v17
    s_add_u32 s8, s4, s16
    s_addc_u32 s9, s5, 0
    s_add_u32 s8, s8, 22020096
    s_addc_u32 s9, s9, 0
    s_and_b32 s9, s9, 0xffff
    s_mov_b32 s10, 65536
    s_mov_b32 s11, 0x20000
    s_mov_b32 s12, s6
    s_and_b32 s13, s7, 0xffff
    s_mov_b32 s14, 2097152
    s_mov_b32 s15, 0x20000
    s_mov_b32 s24, 0
    s_mov_b32 s25, 0
    s_add_u32 s33, s24, 4096
    s_add_u32 s25, s25, 262144
    s_add_u32 s25, s25, 262144
    s_cmp_lg_u32 s22, 0
    s_cbranch_scc1 NOWAIT_34
    s_add_u32 s84, s4, 720896
    s_addc_u32 s85, s5, 0
    s_and_b32 s85, s85, 0xffff
    s_mov_b32 s86, 131072
    s_mov_b32 s87, 0x20000
    v_and_b32 v254, 63, v0
    v_lshlrev_b32 v254, 2, v254
    s_lshr_b32 s89, s20, 1
    s_lshl_b32 s88, s89, 7
    s_add_u32 s88, s88, 24576
    s_mov_b32 exec_lo, 0xffffffff
    s_mov_b32 exec_hi, 0x0
    s_mov_b32 s89, 0x8000
WLP_35:
    buffer_load_dword v255, v254, s[84:87], s88 offen sc1
    s_waitcnt vmcnt(0)
    v_cmp_ne_u32 vcc, 1, v255
    s_sub_u32 s89, s89, 1
    s_cmp_eq_u32 s89, 0
    s_cbranch_scc1 WDN_36
    s_nop 1
    s_cmp_eq_u64 vcc, 0
    s_cbranch_scc0 WLP_35
WDN_36:
    s_mov_b64 exec, -1
NOWAIT_34:
    s_barrier
    buffer_load_dwordx4 a[0:3], v2, s[8:11], s24 offen offset:0 sc1
    buffer_load_dwordx4 a[4:7], v2, s[8:11], s24 offen offset:1024 sc1
    buffer_load_dwordx4 a[8:11], v2, s[8:11], s24 offen offset:2048 sc1
    buffer_load_dwordx4 a[12:15], v2, s[8:11], s24 offen offset:3072 sc1
    buffer_load_dwordx4 a[16:19], v2, s[8:11], s33 offen offset:0 sc1
    buffer_load_dwordx4 a[20:23], v2, s[8:11], s33 offen offset:1024 sc1
    buffer_load_dwordx4 a[24:27], v2, s[8:11], s33 offen offset:2048 sc1
    buffer_load_dwordx4 a[28:31], v2, s[8:11], s33 offen offset:3072 sc1
    s_add_u32 s24, s24, 8192
    s_add_u32 s33, s24, 4096
    buffer_load_dwordx4 a[32:35], v2, s[8:11], s24 offen offset:0 sc1
    buffer_load_dwordx4 a[36:39], v2, s[8:11], s24 offen offset:1024 sc1
    buffer_load_dwordx4 a[40:43], v2, s[8:11], s24 offen offset:2048 sc1
    buffer_load_dwordx4 a[44:47], v2, s[8:11], s24 offen offset:3072 sc1
    buffer_load_dwordx4 a[48:51], v2, s[8:11], s33 offen offset:0 sc1
    buffer_load_dwordx4 a[52:55], v2, s[8:11], s33 offen offset:1024 sc1
    buffer_load_dwordx4 a[56:59], v2, s[8:11], s33 offen offset:2048 sc1
    buffer_load_dwordx4 a[60:63], v2, s[8:11], s33 offen offset:3072 sc1
    s_add_u32 s24, s24, 8192
    s_add_u32 s33, s24, 4096
    buffer_load_dwordx4 a[64:67], v2, s[8:11], s24 offen offset:0 sc1
    buffer_load_dwordx4 a[68:71], v2, s[8:11], s24 offen offset:1024 sc1
    buffer_load_dwordx4 a[72:75], v2, s[8:11], s24 offen offset:2048 sc1
    v_lshrrev_b32 v18, 5, v1
    v_lshlrev_b32 v18, 2, v18
    v_bfe_u32 v19, v1, 2, 2
    v_add_u32 v18, v18, v19
    v_lshlrev_b32 v18, 7, v18
    v_bfe_u32 v19, v1, 4, 1
    v_lshlrev_b32 v19, 1, v19
    v_bfe_u32 v20, v1, 1, 1
    v_add_u32 v19, v19, v20
    v_bfe_u32 v20, v1, 3, 1
    v_lshlrev_b32 v20, 2, v20
    v_xor_b32 v19, v19, v20
    v_lshlrev_b32 v19, 4, v19
    v_add_u32 v18, v18, v19
    v_and_b32 v20, 1, v1
    v_lshlrev_b32 v20, 3, v20
    v_add_u32 v3, v18, v20
    v_xor_b32 v4, 64, v3
    v_add_u32 v3, 4096, v3
    v_add_u32 v4, 4096, v4
    v_mov_b32 v32, 0
    v_mov_b32 v33, 0
    v_mov_b32 v34, 0
    v_mov_b32 v35, 0
    v_mov_b32 v36, 0
    v_mov_b32 v37, 0
    v_mov_b32 v38, 0
    v_mov_b32 v39, 0
    v_mov_b32 v40, 0
    v_mov_b32 v41, 0
    v_mov_b32 v42, 0
    v_mov_b32 v43, 0
    v_mov_b32 v44, 0
    v_mov_b32 v45, 0
    v_mov_b32 v46, 0
    v_mov_b32 v47, 0
    v_mov_b32 v48, 0
    v_mov_b32 v49, 0
    v_mov_b32 v50, 0
    v_mov_b32 v51, 0
    v_mov_b32 v52, 0
    v_mov_b32 v53, 0
    v_mov_b32 v54, 0
    v_mov_b32 v55, 0
    v_mov_b32 v56, 0
    v_mov_b32 v57, 0
    v_mov_b32 v58, 0
    v_mov_b32 v59, 0
    v_mov_b32 v60, 0
    v_mov_b32 v61, 0
    v_mov_b32 v62, 0
    v_mov_b32 v63, 0
    s_mov_b32 s30, 0xffff0000
    v_add_u32 v5, 0, v3
    v_add_u32 v6, 0, v4
    s_mov_b32 s27, 2
    s_waitcnt vmcnt(11)
    s_barrier
    ds_read_b64_tr_b16 v[64:65], v5 offset:0
    ds_read_b64_tr_b16 v[66:67], v5 offset:1024
    ds_read_b64_tr_b16 v[68:69], v6 offset:0
    ds_read_b64_tr_b16 v[70:71], v6 offset:1024
    ds_read_b64_tr_b16 v[72:73], v5 offset:2048
    ds_read_b64_tr_b16 v[74:75], v5 offset:3072
    ds_read_b64_tr_b16 v[76:77], v6 offset:2048
    ds_read_b64_tr_b16 v[78:79], v6 offset:3072
LOOP_32:
    s_cmp_lg_u32 s27, 1
    s_cbranch_scc1 NOEPI_33
    s_lshl_b32 s16, s23, 16
    s_lshl_b32 s17, s21, 12
    s_add_u32 s16, s16, s17
    s_add_u32 s40, s4, s16
    s_addc_u32 s41, s5, 0
    s_add_u32 s40, s40, 1048576
    s_addc_u32 s41, s41, 0
    s_and_b32 s41, s41, 0xffff
    s_mov_b32 s42, 4096
    s_mov_b32 s43, 0x20000
    buffer_load_dwordx4 v[96:99], v2, s[40:43], 0 offen offset:0 sc1
    buffer_load_dwordx4 v[100:103], v2, s[40:43], 0 offen offset:1024 sc1
    buffer_load_dwordx4 v[104:107], v2, s[40:43], 0 offen offset:2048 sc1
    buffer_load_dwordx4 v[108:111], v2, s[40:43], 0 offen offset:3072 sc1
    s_mov_b32 s44, s4
    s_and_b32 s45, s5, 0xffff
    s_mov_b32 s46, 24576
    s_mov_b32 s47, 0x20000
    v_and_b32 v24, 63, v0
    v_lshlrev_b32 v24, 2, v24
    s_lshl_b32 s16, s21, 8
    s_mov_b32 s17, 8192
    s_cmp_eq_u32 s22, 1
    s_cselect_b32 s17, 16384, s17
    s_add_u32 s16, s16, s17
    buffer_load_dword v112, v24, s[44:47], s16 offen sc1
NOEPI_33:
    s_waitcnt lgkmcnt(0)
    v_mfma_f32_32x32x16_bf16 v[32:47], v[64:67], a[0:3], v[32:47]
    ds_read_b64_tr_b16 v[80:81], v5 offset:4096
    ds_read_b64_tr_b16 v[82:83], v5 offset:5120
    ds_read_b64_tr_b16 v[84:85], v6 offset:4096
    v_mfma_f32_32x32x16_bf16 v[48:63], v[68:71], a[0:3], v[48:63]
    ds_read_b64_tr_b16 v[86:87], v6 offset:5120
    ds_read_b64_tr_b16 v[88:89], v5 offset:6144
    ds_read_b64_tr_b16 v[90:91], v5 offset:7168
    buffer_load_dwordx4 a[76:79], v2, s[8:11], s24 offen offset:3072 sc1
    v_mfma_f32_32x32x16_bf16 v[32:47], v[72:75], a[4:7], v[32:47]
    ds_read_b64_tr_b16 v[92:93], v6 offset:6144
    ds_read_b64_tr_b16 v[94:95], v6 offset:7168
    v_mfma_f32_32x32x16_bf16 v[48:63], v[76:79], a[4:7], v[48:63]
    buffer_load_dwordx4 a[80:83], v2, s[8:11], s33 offen offset:0 sc1
    s_waitcnt lgkmcnt(0)
    v_mfma_f32_32x32x16_bf16 v[32:47], v[80:83], a[8:11], v[32:47]
    ds_read_b64_tr_b16 v[64:65], v5 offset:8192
    ds_read_b64_tr_b16 v[66:67], v5 offset:9216
    ds_read_b64_tr_b16 v[68:69], v6 offset:8192
    buffer_load_dwordx4 a[84:87], v2, s[8:11], s33 offen offset:1024 sc1
    v_mfma_f32_32x32x16_bf16 v[48:63], v[84:87], a[8:11], v[48:63]
    ds_read_b64_tr_b16 v[70:71], v6 offset:9216
    ds_read_b64_tr_b16 v[72:73], v5 offset:10240
    ds_read_b64_tr_b16 v[74:75], v5 offset:11264
    v_mfma_f32_32x32x16_bf16 v[32:47], v[88:91], a[12:15], v[32:47]
    ds_read_b64_tr_b16 v[76:77], v6 offset:10240
    ds_read_b64_tr_b16 v[78:79], v6 offset:11264
    buffer_load_dwordx4 a[88:91], v2, s[8:11], s33 offen offset:2048 sc1
    v_mfma_f32_32x32x16_bf16 v[48:63], v[92:95], a[12:15], v[48:63]
    buffer_load_dwordx4 a[92:95], v2, s[8:11], s33 offen offset:3072 sc1
    s_waitcnt lgkmcnt(0)
    v_mfma_f32_32x32x16_bf16 v[32:47], v[64:67], a[16:19], v[32:47]
    ds_read_b64_tr_b16 v[80:81], v5 offset:12288
    ds_read_b64_tr_b16 v[82:83], v5 offset:13312
    ds_read_b64_tr_b16 v[84:85], v6 offset:12288
    v_mfma_f32_32x32x16_bf16 v[48:63], v[68:71], a[16:19], v[48:63]
    ds_read_b64_tr_b16 v[86:87], v6 offset:13312
    ds_read_b64_tr_b16 v[88:89], v5 offset:14336
    ds_read_b64_tr_b16 v[90:91], v5 offset:15360
    v_mfma_f32_32x32x16_bf16 v[32:47], v[72:75], a[20:23], v[32:47]
    ds_read_b64_tr_b16 v[92:93], v6 offset:14336
    ds_read_b64_tr_b16 v[94:95], v6 offset:15360
    v_mfma_f32_32x32x16_bf16 v[48:63], v[76:79], a[20:23], v[48:63]
    s_add_u32 s24, s24, 8192
    s_add_u32 s25, s25, 262144
    s_add_u32 s33, s24, 4096
    s_waitcnt lgkmcnt(0)
    s_waitcnt vmcnt(8)
    v_add_u32 v5, 16384, v3
    v_add_u32 v6, 16384, v4
    v_mfma_f32_32x32x16_bf16 v[32:47], v[80:83], a[24:27], v[32:47]
    ds_read_b64_tr_b16 v[64:65], v5 offset:0
    ds_read_b64_tr_b16 v[66:67], v5 offset:1024
    ds_read_b64_tr_b16 v[68:69], v6 offset:0
    buffer_load_dwordx4 a[96:99], v2, s[8:11], s24 offen offset:0 sc1
    v_mfma_f32_32x32x16_bf16 v[48:63], v[84:87], a[24:27], v[48:63]
    ds_read_b64_tr_b16 v[70:71], v6 offset:1024
    ds_read_b64_tr_b16 v[72:73], v5 offset:2048
    ds_read_b64_tr_b16 v[74:75], v5 offset:3072
    v_mfma_f32_32x32x16_bf16 v[32:47], v[88:91], a[28:31], v[32:47]
    ds_read_b64_tr_b16 v[76:77], v6 offset:2048
    ds_read_b64_tr_b16 v[78:79], v6 offset:3072
    buffer_load_dwordx4 a[100:103], v2, s[8:11], s24 offen offset:1024 sc1
    v_mfma_f32_32x32x16_bf16 v[48:63], v[92:95], a[28:31], v[48:63]
    buffer_load_dwordx4 a[104:107], v2, s[8:11], s24 offen offset:2048 sc1
    s_waitcnt lgkmcnt(0)
    v_mfma_f32_32x32x16_bf16 v[32:47], v[64:67], a[32:35], v[32:47]
    ds_read_b64_tr_b16 v[80:81], v5 offset:4096
    ds_read_b64_tr_b16 v[82:83], v5 offset:5120
    ds_read_b64_tr_b16 v[84:85], v6 offset:4096
    v_mfma_f32_32x32x16_bf16 v[48:63], v[68:71], a[32:35], v[48:63]
    ds_read_b64_tr_b16 v[86:87], v6 offset:5120
    ds_read_b64_tr_b16 v[88:89], v5 offset:6144
    ds_read_b64_tr_b16 v[90:91], v5 offset:7168
    buffer_load_dwordx4 a[108:111], v2, s[8:11], s24 offen offset:3072 sc1
    v_mfma_f32_32x32x16_bf16 v[32:47], v[72:75], a[36:39], v[32:47]
    ds_read_b64_tr_b16 v[92:93], v6 offset:6144
    ds_read_b64_tr_b16 v[94:95], v6 offset:7168
    v_mfma_f32_32x32x16_bf16 v[48:63], v[76:79], a[36:39], v[48:63]
    buffer_load_dwordx4 a[112:115], v2, s[8:11], s33 offen offset:0 sc1
    s_waitcnt lgkmcnt(0)
    v_mfma_f32_32x32x16_bf16 v[32:47], v[80:83], a[40:43], v[32:47]
    ds_read_b64_tr_b16 v[64:65], v5 offset:8192
    ds_read_b64_tr_b16 v[66:67], v5 offset:9216
    ds_read_b64_tr_b16 v[68:69], v6 offset:8192
    buffer_load_dwordx4 a[116:119], v2, s[8:11], s33 offen offset:1024 sc1
    v_mfma_f32_32x32x16_bf16 v[48:63], v[84:87], a[40:43], v[48:63]
    ds_read_b64_tr_b16 v[70:71], v6 offset:9216
    ds_read_b64_tr_b16 v[72:73], v5 offset:10240
    ds_read_b64_tr_b16 v[74:75], v5 offset:11264
    v_mfma_f32_32x32x16_bf16 v[32:47], v[88:91], a[44:47], v[32:47]
    ds_read_b64_tr_b16 v[76:77], v6 offset:10240
    ds_read_b64_tr_b16 v[78:79], v6 offset:11264
    buffer_load_dwordx4 a[120:123], v2, s[8:11], s33 offen offset:2048 sc1
    v_mfma_f32_32x32x16_bf16 v[48:63], v[92:95], a[44:47], v[48:63]
    buffer_load_dwordx4 a[124:127], v2, s[8:11], s33 offen offset:3072 sc1
    s_waitcnt lgkmcnt(0)
    v_mfma_f32_32x32x16_bf16 v[32:47], v[64:67], a[48:51], v[32:47]
    ds_read_b64_tr_b16 v[80:81], v5 offset:12288
    ds_read_b64_tr_b16 v[82:83], v5 offset:13312
    ds_read_b64_tr_b16 v[84:85], v6 offset:12288
    v_mfma_f32_32x32x16_bf16 v[48:63], v[68:71], a[48:51], v[48:63]
    ds_read_b64_tr_b16 v[86:87], v6 offset:13312
    ds_read_b64_tr_b16 v[88:89], v5 offset:14336
    ds_read_b64_tr_b16 v[90:91], v5 offset:15360
    v_mfma_f32_32x32x16_bf16 v[32:47], v[72:75], a[52:55], v[32:47]
    ds_read_b64_tr_b16 v[92:93], v6 offset:14336
    ds_read_b64_tr_b16 v[94:95], v6 offset:15360
    v_mfma_f32_32x32x16_bf16 v[48:63], v[76:79], a[52:55], v[48:63]
    s_add_u32 s24, s24, 8192
    s_add_u32 s25, s25, 262144
    s_add_u32 s33, s24, 4096
    s_waitcnt lgkmcnt(0)
    s_waitcnt vmcnt(8)
    v_add_u32 v5, 32768, v3
    v_add_u32 v6, 32768, v4
    v_mfma_f32_32x32x16_bf16 v[32:47], v[80:83], a[56:59], v[32:47]
    ds_read_b64_tr_b16 v[64:65], v5 offset:0
    ds_read_b64_tr_b16 v[66:67], v5 offset:1024
    ds_read_b64_tr_b16 v[68:69], v6 offset:0
    buffer_load_dwordx4 a[0:3], v2, s[8:11], s24 offen offset:0 sc1
    v_mfma_f32_32x32x16_bf16 v[48:63], v[84:87], a[56:59], v[48:63]
    ds_read_b64_tr_b16 v[70:71], v6 offset:1024
    ds_read_b64_tr_b16 v[72:73], v5 offset:2048
    ds_read_b64_tr_b16 v[74:75], v5 offset:3072
    v_mfma_f32_32x32x16_bf16 v[32:47], v[88:91], a[60:63], v[32:47]
    ds_read_b64_tr_b16 v[76:77], v6 offset:2048
    ds_read_b64_tr_b16 v[78:79], v6 offset:3072
    buffer_load_dwordx4 a[4:7], v2, s[8:11], s24 offen offset:1024 sc1
    v_mfma_f32_32x32x16_bf16 v[48:63], v[92:95], a[60:63], v[48:63]
    buffer_load_dwordx4 a[8:11], v2, s[8:11], s24 offen offset:2048 sc1
    s_waitcnt lgkmcnt(0)
    v_mfma_f32_32x32x16_bf16 v[32:47], v[64:67], a[64:67], v[32:47]
    ds_read_b64_tr_b16 v[80:81], v5 offset:4096
    ds_read_b64_tr_b16 v[82:83], v5 offset:5120
    ds_read_b64_tr_b16 v[84:85], v6 offset:4096
    v_mfma_f32_32x32x16_bf16 v[48:63], v[68:71], a[64:67], v[48:63]
    ds_read_b64_tr_b16 v[86:87], v6 offset:5120
    ds_read_b64_tr_b16 v[88:89], v5 offset:6144
    ds_read_b64_tr_b16 v[90:91], v5 offset:7168
    buffer_load_dwordx4 a[12:15], v2, s[8:11], s24 offen offset:3072 sc1
    v_mfma_f32_32x32x16_bf16 v[32:47], v[72:75], a[68:71], v[32:47]
    ds_read_b64_tr_b16 v[92:93], v6 offset:6144
    ds_read_b64_tr_b16 v[94:95], v6 offset:7168
    v_mfma_f32_32x32x16_bf16 v[48:63], v[76:79], a[68:71], v[48:63]
    buffer_load_dwordx4 a[16:19], v2, s[8:11], s33 offen offset:0 sc1
    s_waitcnt lgkmcnt(0)
    v_mfma_f32_32x32x16_bf16 v[32:47], v[80:83], a[72:75], v[32:47]
    ds_read_b64_tr_b16 v[64:65], v5 offset:8192
    ds_read_b64_tr_b16 v[66:67], v5 offset:9216
    ds_read_b64_tr_b16 v[68:69], v6 offset:8192
    buffer_load_dwordx4 a[20:23], v2, s[8:11], s33 offen offset:1024 sc1
    v_mfma_f32_32x32x16_bf16 v[48:63], v[84:87], a[72:75], v[48:63]
    ds_read_b64_tr_b16 v[70:71], v6 offset:9216
    ds_read_b64_tr_b16 v[72:73], v5 offset:10240
    ds_read_b64_tr_b16 v[74:75], v5 offset:11264
    v_mfma_f32_32x32x16_bf16 v[32:47], v[88:91], a[76:79], v[32:47]
    ds_read_b64_tr_b16 v[76:77], v6 offset:10240
    ds_read_b64_tr_b16 v[78:79], v6 offset:11264
    buffer_load_dwordx4 a[24:27], v2, s[8:11], s33 offen offset:2048 sc1
    v_mfma_f32_32x32x16_bf16 v[48:63], v[92:95], a[76:79], v[48:63]
    buffer_load_dwordx4 a[28:31], v2, s[8:11], s33 offen offset:3072 sc1
    s_waitcnt lgkmcnt(0)
    v_mfma_f32_32x32x16_bf16 v[32:47], v[64:67], a[80:83], v[32:47]
    ds_read_b64_tr_b16 v[80:81], v5 offset:12288
    ds_read_b64_tr_b16 v[82:83], v5 offset:13312
    ds_read_b64_tr_b16 v[84:85], v6 offset:12288
    v_mfma_f32_32x32x16_bf16 v[48:63], v[68:71], a[80:83], v[48:63]
    ds_read_b64_tr_b16 v[86:87], v6 offset:13312
    ds_read_b64_tr_b16 v[88:89], v5 offset:14336
    ds_read_b64_tr_b16 v[90:91], v5 offset:15360
    v_mfma_f32_32x32x16_bf16 v[32:47], v[72:75], a[84:87], v[32:47]
    ds_read_b64_tr_b16 v[92:93], v6 offset:14336
    ds_read_b64_tr_b16 v[94:95], v6 offset:15360
    v_mfma_f32_32x32x16_bf16 v[48:63], v[76:79], a[84:87], v[48:63]
    s_add_u32 s24, s24, 8192
    s_add_u32 s25, s25, 262144
    s_add_u32 s33, s24, 4096
    s_waitcnt lgkmcnt(0)
    s_waitcnt vmcnt(8)
    v_add_u32 v5, 49152, v3
    v_add_u32 v6, 49152, v4
    v_mfma_f32_32x32x16_bf16 v[32:47], v[80:83], a[88:91], v[32:47]
    ds_read_b64_tr_b16 v[64:65], v5 offset:0
    ds_read_b64_tr_b16 v[66:67], v5 offset:1024
    ds_read_b64_tr_b16 v[68:69], v6 offset:0
    buffer_load_dwordx4 a[32:35], v2, s[8:11], s24 offen offset:0 sc1
    v_mfma_f32_32x32x16_bf16 v[48:63], v[84:87], a[88:91], v[48:63]
    ds_read_b64_tr_b16 v[70:71], v6 offset:1024
    ds_read_b64_tr_b16 v[72:73], v5 offset:2048
    ds_read_b64_tr_b16 v[74:75], v5 offset:3072
    v_mfma_f32_32x32x16_bf16 v[32:47], v[88:91], a[92:95], v[32:47]
    ds_read_b64_tr_b16 v[76:77], v6 offset:2048
    ds_read_b64_tr_b16 v[78:79], v6 offset:3072
    buffer_load_dwordx4 a[36:39], v2, s[8:11], s24 offen offset:1024 sc1
    v_mfma_f32_32x32x16_bf16 v[48:63], v[92:95], a[92:95], v[48:63]
    buffer_load_dwordx4 a[40:43], v2, s[8:11], s24 offen offset:2048 sc1
    s_waitcnt lgkmcnt(0)
    v_mfma_f32_32x32x16_bf16 v[32:47], v[64:67], a[96:99], v[32:47]
    ds_read_b64_tr_b16 v[80:81], v5 offset:4096
    ds_read_b64_tr_b16 v[82:83], v5 offset:5120
    ds_read_b64_tr_b16 v[84:85], v6 offset:4096
    v_mfma_f32_32x32x16_bf16 v[48:63], v[68:71], a[96:99], v[48:63]
    ds_read_b64_tr_b16 v[86:87], v6 offset:5120
    ds_read_b64_tr_b16 v[88:89], v5 offset:6144
    ds_read_b64_tr_b16 v[90:91], v5 offset:7168
    buffer_load_dwordx4 a[44:47], v2, s[8:11], s24 offen offset:3072 sc1
    v_mfma_f32_32x32x16_bf16 v[32:47], v[72:75], a[100:103], v[32:47]
    ds_read_b64_tr_b16 v[92:93], v6 offset:6144
    ds_read_b64_tr_b16 v[94:95], v6 offset:7168
    v_mfma_f32_32x32x16_bf16 v[48:63], v[76:79], a[100:103], v[48:63]
    buffer_load_dwordx4 a[48:51], v2, s[8:11], s33 offen offset:0 sc1
    s_waitcnt lgkmcnt(0)
    v_mfma_f32_32x32x16_bf16 v[32:47], v[80:83], a[104:107], v[32:47]
    ds_read_b64_tr_b16 v[64:65], v5 offset:8192
    ds_read_b64_tr_b16 v[66:67], v5 offset:9216
    ds_read_b64_tr_b16 v[68:69], v6 offset:8192
    buffer_load_dwordx4 a[52:55], v2, s[8:11], s33 offen offset:1024 sc1
    v_mfma_f32_32x32x16_bf16 v[48:63], v[84:87], a[104:107], v[48:63]
    ds_read_b64_tr_b16 v[70:71], v6 offset:9216
    ds_read_b64_tr_b16 v[72:73], v5 offset:10240
    ds_read_b64_tr_b16 v[74:75], v5 offset:11264
    v_mfma_f32_32x32x16_bf16 v[32:47], v[88:91], a[108:111], v[32:47]
    ds_read_b64_tr_b16 v[76:77], v6 offset:10240
    ds_read_b64_tr_b16 v[78:79], v6 offset:11264
    buffer_load_dwordx4 a[56:59], v2, s[8:11], s33 offen offset:2048 sc1
    v_mfma_f32_32x32x16_bf16 v[48:63], v[92:95], a[108:111], v[48:63]
    buffer_load_dwordx4 a[60:63], v2, s[8:11], s33 offen offset:3072 sc1
    s_waitcnt lgkmcnt(0)
    v_mfma_f32_32x32x16_bf16 v[32:47], v[64:67], a[112:115], v[32:47]
    ds_read_b64_tr_b16 v[80:81], v5 offset:12288
    ds_read_b64_tr_b16 v[82:83], v5 offset:13312
    ds_read_b64_tr_b16 v[84:85], v6 offset:12288
    v_mfma_f32_32x32x16_bf16 v[48:63], v[68:71], a[112:115], v[48:63]
    ds_read_b64_tr_b16 v[86:87], v6 offset:13312
    ds_read_b64_tr_b16 v[88:89], v5 offset:14336
    ds_read_b64_tr_b16 v[90:91], v5 offset:15360
    v_mfma_f32_32x32x16_bf16 v[32:47], v[72:75], a[116:119], v[32:47]
    ds_read_b64_tr_b16 v[92:93], v6 offset:14336
    ds_read_b64_tr_b16 v[94:95], v6 offset:15360
    v_mfma_f32_32x32x16_bf16 v[48:63], v[76:79], a[116:119], v[48:63]
    s_add_u32 s24, s24, 8192
    s_add_u32 s25, s25, 262144
    s_add_u32 s33, s24, 4096
    s_waitcnt lgkmcnt(0)
    s_waitcnt vmcnt(8)
    v_add_u32 v3, 65536, v3
    v_add_u32 v4, 65536, v4
    v_add_u32 v5, 0, v3
    v_add_u32 v6, 0, v4
    v_mfma_f32_32x32x16_bf16 v[32:47], v[80:83], a[120:123], v[32:47]
    ds_read_b64_tr_b16 v[64:65], v5 offset:0
    ds_read_b64_tr_b16 v[66:67], v5 offset:1024
    ds_read_b64_tr_b16 v[68:69], v6 offset:0
    buffer_load_dwordx4 a[64:67], v2, s[8:11], s24 offen offset:0 sc1
    v_mfma_f32_32x32x16_bf16 v[48:63], v[84:87], a[120:123], v[48:63]
    ds_read_b64_tr_b16 v[70:71], v6 offset:1024
    ds_read_b64_tr_b16 v[72:73], v5 offset:2048
    ds_read_b64_tr_b16 v[74:75], v5 offset:3072
    v_mfma_f32_32x32x16_bf16 v[32:47], v[88:91], a[124:127], v[32:47]
    ds_read_b64_tr_b16 v[76:77], v6 offset:2048
    ds_read_b64_tr_b16 v[78:79], v6 offset:3072
    buffer_load_dwordx4 a[68:71], v2, s[8:11], s24 offen offset:1024 sc1
    v_mfma_f32_32x32x16_bf16 v[48:63], v[92:95], a[124:127], v[48:63]
    buffer_load_dwordx4 a[72:75], v2, s[8:11], s24 offen offset:2048 sc1
    s_sub_u32 s27, s27, 1
    s_cmp_lg_u32 s27, 0
    s_cbranch_scc1 LOOP_32
    s_waitcnt vmcnt(0) lgkmcnt(0)
    v_lshlrev_b32 v16, 2, v0
    v_add_u32 v16, 135168, v16
    v_cmp_gt_u32 vcc, 128, v0
    s_and_saveexec_b64 s[52:53], vcc
    ds_write_b32 v16, v112
    s_mov_b64 exec, s[52:53]
    v_lshrrev_b32 v17, 5, v1
    v_lshlrev_b32 v17, 4, v17
    v_add_u32 v17, 135168, v17
    s_waitcnt lgkmcnt(0)
    s_barrier
    ds_read_b128 v[116:119], v17 offset:0
    ds_read_b128 v[120:123], v17 offset:32
    ds_read_b128 v[124:127], v17 offset:64
    ds_read_b128 v[128:131], v17 offset:96
    ds_read_b128 v[132:135], v17 offset:128
    ds_read_b128 v[136:139], v17 offset:160
    ds_read_b128 v[140:143], v17 offset:192
    ds_read_b128 v[144:147], v17 offset:224
    ds_read_b128 v[148:151], v17 offset:256
    ds_read_b128 v[152:155], v17 offset:288
    ds_read_b128 v[156:159], v17 offset:320
    ds_read_b128 v[160:163], v17 offset:352
    ds_read_b128 v[164:167], v17 offset:384
    ds_read_b128 v[168:171], v17 offset:416
    ds_read_b128 v[172:175], v17 offset:448
    ds_read_b128 v[176:179], v17 offset:480
    s_waitcnt lgkmcnt(8)
    v_lshlrev_b32 v18, 16, v96
    v_and_b32 v19, s30, v96
    v_pk_fma_f32 v[32:33], v[32:33], v[116:117], v[18:19]
    v_cvt_pk_bf16_f32 v64, v32, v33
    v_lshlrev_b32 v20, 16, v97
    v_and_b32 v21, s30, v97
    v_pk_fma_f32 v[34:35], v[34:35], v[118:119], v[20:21]
    v_cvt_pk_bf16_f32 v65, v34, v35
    v_lshlrev_b32 v18, 16, v98
    v_and_b32 v19, s30, v98
    v_pk_fma_f32 v[36:37], v[36:37], v[120:121], v[18:19]
    v_cvt_pk_bf16_f32 v66, v36, v37
    v_lshlrev_b32 v20, 16, v99
    v_and_b32 v21, s30, v99
    v_pk_fma_f32 v[38:39], v[38:39], v[122:123], v[20:21]
    v_cvt_pk_bf16_f32 v67, v38, v39
    v_lshlrev_b32 v18, 16, v100
    v_and_b32 v19, s30, v100
    v_pk_fma_f32 v[40:41], v[40:41], v[124:125], v[18:19]
    v_cvt_pk_bf16_f32 v68, v40, v41
    v_lshlrev_b32 v20, 16, v101
    v_and_b32 v21, s30, v101
    v_pk_fma_f32 v[42:43], v[42:43], v[126:127], v[20:21]
    v_cvt_pk_bf16_f32 v69, v42, v43
    v_lshlrev_b32 v18, 16, v102
    v_and_b32 v19, s30, v102
    v_pk_fma_f32 v[44:45], v[44:45], v[128:129], v[18:19]
    v_cvt_pk_bf16_f32 v70, v44, v45
    v_lshlrev_b32 v20, 16, v103
    v_and_b32 v21, s30, v103
    v_pk_fma_f32 v[46:47], v[46:47], v[130:131], v[20:21]
    v_cvt_pk_bf16_f32 v71, v46, v47
    v_lshlrev_b32 v18, 16, v104
    v_and_b32 v19, s30, v104
    v_pk_fma_f32 v[48:49], v[48:49], v[132:133], v[18:19]
    v_cvt_pk_bf16_f32 v72, v48, v49
    v_lshlrev_b32 v20, 16, v105
    v_and_b32 v21, s30, v105
    v_pk_fma_f32 v[50:51], v[50:51], v[134:135], v[20:21]
    v_cvt_pk_bf16_f32 v73, v50, v51
    v_lshlrev_b32 v18, 16, v106
    v_and_b32 v19, s30, v106
    v_pk_fma_f32 v[52:53], v[52:53], v[136:137], v[18:19]
    v_cvt_pk_bf16_f32 v74, v52, v53
    v_lshlrev_b32 v20, 16, v107
    v_and_b32 v21, s30, v107
    v_pk_fma_f32 v[54:55], v[54:55], v[138:139], v[20:21]
    v_cvt_pk_bf16_f32 v75, v54, v55
    v_lshlrev_b32 v18, 16, v108
    v_and_b32 v19, s30, v108
    v_pk_fma_f32 v[56:57], v[56:57], v[140:141], v[18:19]
    v_cvt_pk_bf16_f32 v76, v56, v57
    v_lshlrev_b32 v20, 16, v109
    v_and_b32 v21, s30, v109
    v_pk_fma_f32 v[58:59], v[58:59], v[142:143], v[20:21]
    v_cvt_pk_bf16_f32 v77, v58, v59
    v_lshlrev_b32 v18, 16, v110
    v_and_b32 v19, s30, v110
    v_pk_fma_f32 v[60:61], v[60:61], v[144:145], v[18:19]
    v_cvt_pk_bf16_f32 v78, v60, v61
    v_lshlrev_b32 v20, 16, v111
    v_and_b32 v21, s30, v111
    v_pk_fma_f32 v[62:63], v[62:63], v[146:147], v[20:21]
    v_cvt_pk_bf16_f32 v79, v62, v63
    s_lshl_b32 s16, s23, 16
    s_lshl_b32 s17, s21, 12
    s_add_u32 s16, s16, s17
    s_add_u32 s40, s4, s16
    s_addc_u32 s41, s5, 0
    s_add_u32 s40, s40, 26214400
    s_addc_u32 s41, s41, 0
    s_and_b32 s41, s41, 0xffff
    s_mov_b32 s42, 4096
    s_mov_b32 s43, 0x20000
    s_add_u32 s44, s4, s16
    s_addc_u32 s45, s5, 0
    s_add_u32 s44, s44, 30408704
    s_addc_u32 s45, s45, 0
    s_and_b32 s45, s45, 0xffff
    s_mov_b32 s46, 4096
    s_mov_b32 s47, 0x20000
    buffer_store_dwordx4 v[64:67], v2, s[40:43], 0 offen offset:0 sc1
    buffer_store_dwordx4 v[68:71], v2, s[40:43], 0 offen offset:1024 sc1
    buffer_store_dwordx4 v[72:75], v2, s[40:43], 0 offen offset:2048 sc1
    buffer_store_dwordx4 v[76:79], v2, s[40:43], 0 offen offset:3072 sc1
    s_waitcnt lgkmcnt(0)
    v_lshlrev_b32 v32, 16, v64
    v_and_b32 v33, s30, v64
    v_pk_mul_f32 v[148:149], v[148:149], v[32:33]
    v_cvt_pk_bf16_f32 v116, v148, v149
    v_lshlrev_b32 v34, 16, v65
    v_and_b32 v35, s30, v65
    v_pk_mul_f32 v[150:151], v[150:151], v[34:35]
    v_cvt_pk_bf16_f32 v117, v150, v151
    v_lshlrev_b32 v36, 16, v66
    v_and_b32 v37, s30, v66
    v_pk_mul_f32 v[152:153], v[152:153], v[36:37]
    v_cvt_pk_bf16_f32 v118, v152, v153
    v_lshlrev_b32 v38, 16, v67
    v_and_b32 v39, s30, v67
    v_pk_mul_f32 v[154:155], v[154:155], v[38:39]
    v_cvt_pk_bf16_f32 v119, v154, v155
    v_lshlrev_b32 v40, 16, v68
    v_and_b32 v41, s30, v68
    v_pk_mul_f32 v[156:157], v[156:157], v[40:41]
    v_cvt_pk_bf16_f32 v120, v156, v157
    v_lshlrev_b32 v42, 16, v69
    v_and_b32 v43, s30, v69
    v_pk_mul_f32 v[158:159], v[158:159], v[42:43]
    v_cvt_pk_bf16_f32 v121, v158, v159
    v_lshlrev_b32 v44, 16, v70
    v_and_b32 v45, s30, v70
    v_pk_mul_f32 v[160:161], v[160:161], v[44:45]
    v_cvt_pk_bf16_f32 v122, v160, v161
    v_lshlrev_b32 v46, 16, v71
    v_and_b32 v47, s30, v71
    v_pk_mul_f32 v[162:163], v[162:163], v[46:47]
    v_cvt_pk_bf16_f32 v123, v162, v163
    v_lshlrev_b32 v48, 16, v72
    v_and_b32 v49, s30, v72
    v_pk_mul_f32 v[164:165], v[164:165], v[48:49]
    v_cvt_pk_bf16_f32 v124, v164, v165
    v_lshlrev_b32 v50, 16, v73
    v_and_b32 v51, s30, v73
    v_pk_mul_f32 v[166:167], v[166:167], v[50:51]
    v_cvt_pk_bf16_f32 v125, v166, v167
    v_lshlrev_b32 v52, 16, v74
    v_and_b32 v53, s30, v74
    v_pk_mul_f32 v[168:169], v[168:169], v[52:53]
    v_cvt_pk_bf16_f32 v126, v168, v169
    v_lshlrev_b32 v54, 16, v75
    v_and_b32 v55, s30, v75
    v_pk_mul_f32 v[170:171], v[170:171], v[54:55]
    v_cvt_pk_bf16_f32 v127, v170, v171
    v_lshlrev_b32 v56, 16, v76
    v_and_b32 v57, s30, v76
    v_pk_mul_f32 v[172:173], v[172:173], v[56:57]
    v_cvt_pk_bf16_f32 v128, v172, v173
    v_lshlrev_b32 v58, 16, v77
    v_and_b32 v59, s30, v77
    v_pk_mul_f32 v[174:175], v[174:175], v[58:59]
    v_cvt_pk_bf16_f32 v129, v174, v175
    v_lshlrev_b32 v60, 16, v78
    v_and_b32 v61, s30, v78
    v_pk_mul_f32 v[176:177], v[176:177], v[60:61]
    v_cvt_pk_bf16_f32 v130, v176, v177
    v_lshlrev_b32 v62, 16, v79
    v_and_b32 v63, s30, v79
    v_pk_mul_f32 v[178:179], v[178:179], v[62:63]
    v_cvt_pk_bf16_f32 v131, v178, v179
    buffer_store_dwordx4 v[116:119], v2, s[44:47], 0 offen offset:0 sc1
    buffer_store_dwordx4 v[120:123], v2, s[44:47], 0 offen offset:1024 sc1
    buffer_store_dwordx4 v[124:127], v2, s[44:47], 0 offen offset:2048 sc1
    buffer_store_dwordx4 v[128:131], v2, s[44:47], 0 offen offset:3072 sc1
    v_pk_add_f32 v[18:19], v[32:33], v[34:35]
    v_pk_add_f32 v[18:19], v[18:19], v[36:37]
    v_pk_add_f32 v[18:19], v[18:19], v[38:39]
    v_pk_add_f32 v[18:19], v[18:19], v[40:41]
    v_pk_add_f32 v[18:19], v[18:19], v[42:43]
    v_pk_add_f32 v[18:19], v[18:19], v[44:45]
    v_pk_add_f32 v[18:19], v[18:19], v[46:47]
    v_pk_add_f32 v[18:19], v[18:19], v[48:49]
    v_pk_add_f32 v[18:19], v[18:19], v[50:51]
    v_pk_add_f32 v[18:19], v[18:19], v[52:53]
    v_pk_add_f32 v[18:19], v[18:19], v[54:55]
    v_pk_add_f32 v[18:19], v[18:19], v[56:57]
    v_pk_add_f32 v[18:19], v[18:19], v[58:59]
    v_pk_add_f32 v[18:19], v[18:19], v[60:61]
    v_pk_add_f32 v[18:19], v[18:19], v[62:63]
    v_add_f32 v16, v18, v19
    v_mov_b32 v17, v16
    s_nop 1
    v_permlane32_swap_b32 v16, v17
    s_nop 1
    v_add_f32 v16, v16, v17
    v_mul_f32 v16, 0x3c800000, v16
    v_sub_f32 v20, 0, v16
    v_mov_b32 v21, v20
    v_mov_b32 v18, 0
    v_mov_b32 v19, 0
    v_pk_add_f32 v[32:33], v[32:33], v[20:21]
    v_pk_add_f32 v[34:35], v[34:35], v[20:21]
    v_pk_add_f32 v[36:37], v[36:37], v[20:21]
    v_pk_add_f32 v[38:39], v[38:39], v[20:21]
    v_pk_add_f32 v[40:41], v[40:41], v[20:21]
    v_pk_add_f32 v[42:43], v[42:43], v[20:21]
    v_pk_add_f32 v[44:45], v[44:45], v[20:21]
    v_pk_add_f32 v[46:47], v[46:47], v[20:21]
    v_pk_add_f32 v[48:49], v[48:49], v[20:21]
    v_pk_add_f32 v[50:51], v[50:51], v[20:21]
    v_pk_add_f32 v[52:53], v[52:53], v[20:21]
    v_pk_add_f32 v[54:55], v[54:55], v[20:21]
    v_pk_add_f32 v[56:57], v[56:57], v[20:21]
    v_pk_add_f32 v[58:59], v[58:59], v[20:21]
    v_pk_add_f32 v[60:61], v[60:61], v[20:21]
    v_pk_add_f32 v[62:63], v[62:63], v[20:21]
    v_pk_fma_f32 v[18:19], v[32:33], v[32:33], v[18:19]
    v_pk_fma_f32 v[18:19], v[34:35], v[34:35], v[18:19]
    v_pk_fma_f32 v[18:19], v[36:37], v[36:37], v[18:19]
    v_pk_fma_f32 v[18:19], v[38:39], v[38:39], v[18:19]
    v_pk_fma_f32 v[18:19], v[40:41], v[40:41], v[18:19]
    v_pk_fma_f32 v[18:19], v[42:43], v[42:43], v[18:19]
    v_pk_fma_f32 v[18:19], v[44:45], v[44:45], v[18:19]
    v_pk_fma_f32 v[18:19], v[46:47], v[46:47], v[18:19]
    v_pk_fma_f32 v[18:19], v[48:49], v[48:49], v[18:19]
    v_pk_fma_f32 v[18:19], v[50:51], v[50:51], v[18:19]
    v_pk_fma_f32 v[18:19], v[52:53], v[52:53], v[18:19]
    v_pk_fma_f32 v[18:19], v[54:55], v[54:55], v[18:19]
    v_pk_fma_f32 v[18:19], v[56:57], v[56:57], v[18:19]
    v_pk_fma_f32 v[18:19], v[58:59], v[58:59], v[18:19]
    v_pk_fma_f32 v[18:19], v[60:61], v[60:61], v[18:19]
    v_pk_fma_f32 v[18:19], v[62:63], v[62:63], v[18:19]
    v_add_f32 v17, v18, v19
    v_mov_b32 v20, v17
    s_nop 1
    v_permlane32_swap_b32 v17, v20
    s_nop 1
    v_add_f32 v17, v17, v20
    s_add_u32 s48, s4, 262144
    s_addc_u32 s49, s5, 0
    s_and_b32 s49, s49, 0xffff
    s_mov_b32 s50, 262144
    s_mov_b32 s51, 0x20000
    v_and_b32 v22, 31, v1
    v_lshlrev_b32 v22, 3, v22
    s_lshl_b32 s16, s21, 14
    s_lshl_b32 s17, s23, 8
    s_add_u32 s16, s16, s17
    v_cmp_gt_u32 vcc, 32, v1
    s_and_saveexec_b64 s[52:53], vcc
    buffer_store_dwordx2 v[16:17], v22, s[48:51], s16 offen sc1
    s_mov_b64 exec, s[52:53]
    s_mov_b64 exec, -1
    s_waitcnt vmcnt(0)
    s_barrier
    s_cmp_lg_u32 s22, 0
    s_cbranch_scc1 NOSIG_37
    s_add_u32 s84, s4, 720896
    s_addc_u32 s85, s5, 0
    s_and_b32 s85, s85, 0xffff
    s_mov_b32 s86, 131072
    s_mov_b32 s87, 0x20000
    s_lshl_b32 s88, s20, 7
    s_add_u32 s88, s88, 0
    s_lshl_b32 s89, s21, 2
    s_add_u32 s88, s88, s89
    s_mov_b64 exec, 1
    v_mov_b32 v254, 1
    v_mov_b32 v255, s88
    buffer_store_dword v254, v255, s[84:87], 0 offen sc1
    s_mov_b64 exec, -1
NOSIG_37:
PHF1_18:
    s_mov_b64 s[6:7], s[98:99]
    v_lshrrev_b32 v16, 6, v0
    v_and_b32 v1, 63, v0
    v_readfirstlane_b32 s22, v16
    s_and_b32 s16, s2, 7
    s_lshr_b32 s17, s2, 3
    s_lshr_b32 s18, s16, 2
    s_lshl_b32 s18, s18, 3
    s_lshr_b32 s19, s17, 2
    s_add_u32 s20, s18, s19
    s_and_b32 s18, s16, 3
    s_lshl_b32 s18, s18, 2
    s_and_b32 s19, s17, 3
    s_add_u32 s21, s18, s19
    s_lshl_b32 s23, s20, 2
    s_add_u32 s23, s23, s22
    s_mul_i32 s16, s23, 65536
    v_lshlrev_b32 v2, 4, v1
    s_mul_i32 s17, s22, 114688
    s_mul_i32 s18, s21, 448
    s_add_u32 s17, s17, s18
    s_mul_i32 s26, s22, 7168
    v_add_u32 v17, 0, v1
    v_mul_u32_u24 v18, 2341, v17
    v_lshrrev_b32 v18, 16, v18
    v_mul_u32_u24 v19, 28, v18
    v_sub_u32 v19, v17, v19
    v_mul_u32_u24 v18, 7168, v18
    v_lshl_add_u32 v18, v19, 4, v18
    v_add_u32 v8, s17, v18
    v_add_u32 v17, 64, v1
    v_mul_u32_u24 v18, 2341, v17
    v_lshrrev_b32 v18, 16, v18
    v_mul_u32_u24 v19, 28, v18
    v_sub_u32 v19, v17, v19
    v_mul_u32_u24 v18, 7168, v18
    v_lshl_add_u32 v18, v19, 4, v18
    v_add_u32 v9, s17, v18
    v_add_u32 v17, 128, v1
    v_mul_u32_u24 v18, 2341, v17
    v_lshrrev_b32 v18, 16, v18
    v_mul_u32_u24 v19, 28, v18
    v_sub_u32 v19, v17, v19
    v_mul_u32_u24 v18, 7168, v18
    v_lshl_add_u32 v18, v19, 4, v18
    v_add_u32 v10, s17, v18
    v_add_u32 v17, 192, v1
    v_mul_u32_u24 v18, 2341, v17
    v_lshrrev_b32 v18, 16, v18
    v_mul_u32_u24 v19, 28, v18
    v_sub_u32 v19, v17, v19
    v_mul_u32_u24 v18, 7168, v18
    v_lshl_add_u32 v18, v19, 4, v18
    v_add_u32 v11, s17, v18
    v_add_u32 v17, 256, v1
    v_mul_u32_u24 v18, 2341, v17
    v_lshrrev_b32 v18, 16, v18
    v_mul_u32_u24 v19, 28, v18
    v_sub_u32 v19, v17, v19
    v_mul_u32_u24 v18, 7168, v18
    v_lshl_add_u32 v18, v19, 4, v18
    v_add_u32 v12, s17, v18
    v_add_u32 v17, 320, v1
    v_mul_u32_u24 v18, 2341, v17
    v_lshrrev_b32 v18, 16, v18
    v_mul_u32_u24 v19, 28, v18
    v_sub_u32 v19, v17, v19
    v_mul_u32_u24 v18, 7168, v18
    v_lshl_add_u32 v18, v19, 4, v18
    v_add_u32 v13, s17, v18
    v_add_u32 v17, 384, v1
    v_mul_u32_u24 v18, 2341, v17
    v_lshrrev_b32 v18, 16, v18
    v_mul_u32_u24 v19, 28, v18
    v_sub_u32 v19, v17, v19
    v_mul_u32_u24 v18, 7168, v18
    v_lshl_add_u32 v18, v19, 4, v18
    v_add_u32 v14, s17, v18
    s_add_u32 s8, s4, s16
    s_addc_u32 s9, s5, 0
    s_add_u32 s8, s8, 30408704
    s_addc_u32 s9, s9, 0
    s_and_b32 s9, s9, 0xffff
    s_mov_b32 s10, 65536
    s_mov_b32 s11, 0x20000
    s_mov_b32 s12, s6
    s_and_b32 s13, s7, 0xffff
    s_mov_b32 s14, 7340032
    s_mov_b32 s15, 0x20000
    s_mov_b32 s24, 0
    s_mov_b32 s25, 0
    s_add_u32 m0, s26, 0
    s_nop 0
    buffer_load_dwordx4 v8, s[12:15], s25 offen lds
    s_add_u32 m0, s26, 1024
    s_nop 0
    buffer_load_dwordx4 v9, s[12:15], s25 offen lds
    s_add_u32 m0, s26, 2048
    s_nop 0
    buffer_load_dwordx4 v10, s[12:15], s25 offen lds
    s_add_u32 m0, s26, 3072
    s_nop 0
    buffer_load_dwordx4 v11, s[12:15], s25 offen lds
    s_add_u32 m0, s26, 4096
    s_nop 0
    buffer_load_dwordx4 v12, s[12:15], s25 offen lds
    s_add_u32 m0, s26, 5120
    s_nop 0
    buffer_load_dwordx4 v13, s[12:15], s25 offen lds
    s_add_u32 m0, s26, 6144
    s_nop 0
    buffer_load_dwordx4 v14, s[12:15], s25 offen lds
    s_add_u32 s25, s25, 458752
    s_add_u32 m0, s26, 28672
    s_nop 0
    buffer_load_dwordx4 v8, s[12:15], s25 offen lds
    s_add_u32 m0, s26, 29696
    s_nop 0
    buffer_load_dwordx4 v9, s[12:15], s25 offen lds
    s_add_u32 m0, s26, 30720
    s_nop 0
    buffer_load_dwordx4 v10, s[12:15], s25 offen lds
    s_add_u32 m0, s26, 31744
    s_nop 0
    buffer_load_dwordx4 v11, s[12:15], s25 offen lds
    s_add_u32 m0, s26, 32768
    s_nop 0
    buffer_load_dwordx4 v12, s[12:15], s25 offen lds
    s_add_u32 m0, s26, 33792
    s_nop 0
    buffer_load_dwordx4 v13, s[12:15], s25 offen lds
    s_add_u32 m0, s26, 34816
    s_nop 0
    buffer_load_dwordx4 v14, s[12:15], s25 offen lds
    s_add_u32 s25, s25, 458752
    s_cmp_lg_u32 s22, 0
    s_cbranch_scc1 NOWAIT_41
    s_add_u32 s84, s4, 720896
    s_addc_u32 s85, s5, 0
    s_and_b32 s85, s85, 0xffff
    s_mov_b32 s86, 131072
    s_mov_b32 s87, 0x20000
    v_and_b32 v254, 63, v0
    v_lshlrev_b32 v254, 2, v254
    s_lshl_b32 s88, s20, 7
    s_add_u32 s88, s88, 0
    s_mov_b32 exec_lo, 0xffff
    s_mov_b32 exec_hi, 0x0
    s_mov_b32 s89, 0x8000
WLP_42:
    buffer_load_dword v255, v254, s[84:87], s88 offen sc1
    s_waitcnt vmcnt(0)
    v_cmp_ne_u32 vcc, 1, v255
    s_sub_u32 s89, s89, 1
    s_cmp_eq_u32 s89, 0
    s_cbranch_scc1 WDN_43
    s_nop 1
    s_cmp_eq_u64 vcc, 0
    s_cbranch_scc0 WLP_42
WDN_43:
    s_mov_b64 exec, -1
    s_mul_i32 s89, s21, 7
    s_lshr_b32 s89, s89, 1
    s_lshl_b32 s88, s89, 4
    s_add_u32 s88, s88, 32768
    s_mov_b32 exec_lo, 0xffff
    s_mov_b32 exec_hi, 0x0
    s_mov_b32 s89, 0x8000
WLP_44:
    buffer_load_dword v255, v254, s[84:87], s88 offen sc1
    s_waitcnt vmcnt(0)
    v_cmp_ne_u32 vcc, 1, v255
    s_sub_u32 s89, s89, 1
    s_cmp_eq_u32 s89, 0
    s_cbranch_scc1 WDN_45
    s_nop 1
    s_cmp_eq_u64 vcc, 0
    s_cbranch_scc0 WLP_44
WDN_45:
    s_mov_b64 exec, -1
NOWAIT_41:
    s_barrier
    buffer_load_dwordx4 a[0:3], v2, s[8:11], s24 offen offset:0 sc1
    buffer_load_dwordx4 a[4:7], v2, s[8:11], s24 offen offset:1024 sc1
    buffer_load_dwordx4 a[8:11], v2, s[8:11], s24 offen offset:2048 sc1
    buffer_load_dwordx4 a[12:15], v2, s[8:11], s24 offen offset:3072 sc1
    s_add_u32 s24, s24, 4096
    buffer_load_dwordx4 a[16:19], v2, s[8:11], s24 offen offset:0 sc1
    buffer_load_dwordx4 a[20:23], v2, s[8:11], s24 offen offset:1024 sc1
    buffer_load_dwordx4 a[24:27], v2, s[8:11], s24 offen offset:2048 sc1
    buffer_load_dwordx4 a[28:31], v2, s[8:11], s24 offen offset:3072 sc1
    s_add_u32 s24, s24, 4096
    s_add_u32 m0, s26, 57344
    s_nop 0
    buffer_load_dwordx4 v8, s[12:15], s25 offen lds
    s_add_u32 m0, s26, 58368
    s_nop 0
    buffer_load_dwordx4 v9, s[12:15], s25 offen lds
    s_add_u32 m0, s26, 59392
    s_nop 0
    buffer_load_dwordx4 v10, s[12:15], s25 offen lds
    s_add_u32 m0, s26, 60416
    s_nop 0
    buffer_load_dwordx4 v11, s[12:15], s25 offen lds
    v_lshrrev_b32 v17, 5, v1
    v_lshlrev_b32 v17, 2, v17
    v_bfe_u32 v18, v1, 2, 2
    v_add_u32 v17, v17, v18
    v_mul_u32_u24 v17, 448, v17
    v_bfe_u32 v18, v1, 4, 1
    v_lshlrev_b32 v18, 5, v18
    v_and_b32 v19, 3, v1
    v_lshlrev_b32 v19, 3, v19
    v_add3_u32 v3, v17, v18, v19
    v_mov_b32 v32, 0
    v_mov_b32 v33, 0
    v_mov_b32 v34, 0
    v_mov_b32 v35, 0
    v_mov_b32 v36, 0
    v_mov_b32 v37, 0
    v_mov_b32 v38, 0
    v_mov_b32 v39, 0
    v_mov_b32 v40, 0
    v_mov_b32 v41, 0
    v_mov_b32 v42, 0
    v_mov_b32 v43, 0
    v_mov_b32 v44, 0
    v_mov_b32 v45, 0
    v_mov_b32 v46, 0
    v_mov_b32 v47, 0
    v_mov_b32 v48, 0
    v_mov_b32 v49, 0
    v_mov_b32 v50, 0
    v_mov_b32 v51, 0
    v_mov_b32 v52, 0
    v_mov_b32 v53, 0
    v_mov_b32 v54, 0
    v_mov_b32 v55, 0
    v_mov_b32 v56, 0
    v_mov_b32 v57, 0
    v_mov_b32 v58, 0
    v_mov_b32 v59, 0
    v_mov_b32 v60, 0
    v_mov_b32 v61, 0
    v_mov_b32 v62, 0
    v_mov_b32 v63, 0
    v_mov_b32 v64, 0
    v_mov_b32 v65, 0
    v_mov_b32 v66, 0
    v_mov_b32 v67, 0
    v_mov_b32 v68, 0
    v_mov_b32 v69, 0
    v_mov_b32 v70, 0
    v_mov_b32 v71, 0
    v_mov_b32 v72, 0
    v_mov_b32 v73, 0
    v_mov_b32 v74, 0
    v_mov_b32 v75, 0
    v_mov_b32 v76, 0
    v_mov_b32 v77, 0
    v_mov_b32 v78, 0
    v_mov_b32 v79, 0
    v_mov_b32 v80, 0
    v_mov_b32 v81, 0
    v_mov_b32 v82, 0
    v_mov_b32 v83, 0
    v_mov_b32 v84, 0
    v_mov_b32 v85, 0
    v_mov_b32 v86, 0
    v_mov_b32 v87, 0
    v_mov_b32 v88, 0
    v_mov_b32 v89, 0
    v_mov_b32 v90, 0
    v_mov_b32 v91, 0
    v_mov_b32 v92, 0
    v_mov_b32 v93, 0
    v_mov_b32 v94, 0
    v_mov_b32 v95, 0
    v_mov_b32 v96, 0
    v_mov_b32 v97, 0
    v_mov_b32 v98, 0
    v_mov_b32 v99, 0
    v_mov_b32 v100, 0
    v_mov_b32 v101, 0
    v_mov_b32 v102, 0
    v_mov_b32 v103, 0
    v_mov_b32 v104, 0
    v_mov_b32 v105, 0
    v_mov_b32 v106, 0
    v_mov_b32 v107, 0
    v_mov_b32 v108, 0
    v_mov_b32 v109, 0
    v_mov_b32 v110, 0
    v_mov_b32 v111, 0
    v_mov_b32 v112, 0
    v_mov_b32 v113, 0
    v_mov_b32 v114, 0
    v_mov_b32 v115, 0
    v_mov_b32 v116, 0
    v_mov_b32 v117, 0
    v_mov_b32 v118, 0
    v_mov_b32 v119, 0
    v_mov_b32 v120, 0
    v_mov_b32 v121, 0
    v_mov_b32 v122, 0
    v_mov_b32 v123, 0
    v_mov_b32 v124, 0
    v_mov_b32 v125, 0
    v_mov_b32 v126, 0
    v_mov_b32 v127, 0
    v_mov_b32 v128, 0
    v_mov_b32 v129, 0
    v_mov_b32 v130, 0
    v_mov_b32 v131, 0
    v_mov_b32 v132, 0
    v_mov_b32 v133, 0
    v_mov_b32 v134, 0
    v_mov_b32 v135, 0
    v_mov_b32 v136, 0
    v_mov_b32 v137, 0
    v_mov_b32 v138, 0
    v_mov_b32 v139, 0
    v_mov_b32 v140, 0
    v_mov_b32 v141, 0
    v_mov_b32 v142, 0
    v_mov_b32 v143, 0
    s_mov_b32 s30, 0xffff0000
    v_add_u32 v5, 0, v3
    s_mov_b32 s27, 4
    s_waitcnt vmcnt(8)
    s_barrier
    ds_read_b64_tr_b16 v[144:145], v5 offset:0
    ds_read_b64_tr_b16 v[146:147], v5 offset:3584
    ds_read_b64_tr_b16 v[148:149], v5 offset:64
    ds_read_b64_tr_b16 v[150:151], v5 offset:3648
    ds_read_b64_tr_b16 v[152:153], v5 offset:128
    ds_read_b64_tr_b16 v[154:155], v5 offset:3712
    ds_read_b64_tr_b16 v[156:157], v5 offset:192
    ds_read_b64_tr_b16 v[158:159], v5 offset:3776
    ds_read_b64_tr_b16 v[160:161], v5 offset:256
    ds_read_b64_tr_b16 v[162:163], v5 offset:3840
    ds_read_b64_tr_b16 v[164:165], v5 offset:320
    ds_read_b64_tr_b16 v[166:167], v5 offset:3904
    ds_read_b64_tr_b16 v[168:169], v5 offset:384
    ds_read_b64_tr_b16 v[170:171], v5 offset:3968
LOOP_39:
    s_cmp_lg_u32 s27, 1
    s_cbranch_scc1 NOEPI_40
    s_add_u32 s40, s4, 262144
    s_addc_u32 s41, s5, 0
    s_and_b32 s41, s41, 0xffff
    s_mov_b32 s42, 262144
    s_mov_b32 s43, 0x20000
    v_and_b32 v25, 31, v1
    v_lshlrev_b32 v25, 3, v25
    s_lshl_b32 s16, s23, 8
    buffer_load_dwordx2 v[200:201], v25, s[40:43], s16 offen sc1
    s_add_u32 s16, s16, 16384
    buffer_load_dwordx2 v[202:203], v25, s[40:43], s16 offen sc1
    s_add_u32 s16, s16, 16384
    buffer_load_dwordx2 v[204:205], v25, s[40:43], s16 offen sc1
    s_add_u32 s16, s16, 16384
    buffer_load_dwordx2 v[206:207], v25, s[40:43], s16 offen sc1
    s_add_u32 s16, s16, 16384
    buffer_load_dwordx2 v[208:209], v25, s[40:43], s16 offen sc1
    s_add_u32 s16, s16, 16384
    buffer_load_dwordx2 v[210:211], v25, s[40:43], s16 offen sc1
    s_add_u32 s16, s16, 16384
    buffer_load_dwordx2 v[212:213], v25, s[40:43], s16 offen sc1
    s_add_u32 s16, s16, 16384
    buffer_load_dwordx2 v[214:215], v25, s[40:43], s16 offen sc1
    s_add_u32 s16, s16, 16384
    buffer_load_dwordx2 v[216:217], v25, s[40:43], s16 offen sc1
    s_add_u32 s16, s16, 16384
    buffer_load_dwordx2 v[218:219], v25, s[40:43], s16 offen sc1
    s_add_u32 s16, s16, 16384
    buffer_load_dwordx2 v[220:221], v25, s[40:43], s16 offen sc1
    s_add_u32 s16, s16, 16384
    buffer_load_dwordx2 v[222:223], v25, s[40:43], s16 offen sc1
    s_add_u32 s16, s16, 16384
    buffer_load_dwordx2 v[224:225], v25, s[40:43], s16 offen sc1
    s_add_u32 s16, s16, 16384
    buffer_load_dwordx2 v[226:227], v25, s[40:43], s16 offen sc1
    s_add_u32 s16, s16, 16384
    buffer_load_dwordx2 v[228:229], v25, s[40:43], s16 offen sc1
    s_add_u32 s16, s16, 16384
    buffer_load_dwordx2 v[230:231], v25, s[40:43], s16 offen sc1
    s_add_u32 s44, s4, 65536
    s_addc_u32 s45, s5, 0
    s_and_b32 s45, s45, 0xffff
    s_mov_b32 s46, 114688
    s_mov_b32 s47, 0x20000
    v_lshlrev_b32 v24, 2, v0
    s_mul_i32 s16, s21, 896
    s_add_u32 s17, s16, 0
    buffer_load_dword v232, v24, s[44:47], s17 offen sc1
    s_add_u32 s17, s16, 14336
    buffer_load_dword v236, v24, s[44:47], s17 offen sc1
    s_add_u32 s17, s16, 28672
    buffer_load_dword v233, v24, s[44:47], s17 offen sc1
    s_add_u32 s17, s16, 43008
    buffer_load_dword v237, v24, s[44:47], s17 offen sc1
    s_add_u32 s17, s16, 57344
    buffer_load_dword v234, v24, s[44:47], s17 offen sc1
    s_add_u32 s17, s16, 71680
    buffer_load_dword v238, v24, s[44:47], s17 offen sc1
    s_add_u32 s17, s16, 86016
    buffer_load_dword v235, v24, s[44:47], s17 offen sc1
    s_add_u32 s17, s16, 100352
    buffer_load_dword v239, v24, s[44:47], s17 offen sc1
NOEPI_40:
    s_waitcnt lgkmcnt(0)
    v_mfma_f32_32x32x16_bf16 v[32:47], v[144:147], a[0:3], v[32:47]
    ds_read_b64_tr_b16 v[172:173], v5 offset:7168
    ds_read_b64_tr_b16 v[174:175], v5 offset:10752
    ds_read_b64_tr_b16 v[176:177], v5 offset:7232
    v_mfma_f32_32x32x16_bf16 v[48:63], v[148:151], a[0:3], v[48:63]
    s_add_u32 m0, s26, 61440
    ds_read_b64_tr_b16 v[178:179], v5 offset:10816
    buffer_load_dwordx4 v12, s[12:15], s25 offen lds
    ds_read_b64_tr_b16 v[180:181], v5 offset:7296
    ds_read_b64_tr_b16 v[182:183], v5 offset:10880
    v_mfma_f32_32x32x16_bf16 v[64:79], v[152:155], a[0:3], v[64:79]
    ds_read_b64_tr_b16 v[184:185], v5 offset:7360
    ds_read_b64_tr_b16 v[186:187], v5 offset:10944
    ds_read_b64_tr_b16 v[188:189], v5 offset:7424
    v_mfma_f32_32x32x16_bf16 v[80:95], v[156:159], a[0:3], v[80:95]
    s_add_u32 m0, s26, 62464
    ds_read_b64_tr_b16 v[190:191], v5 offset:11008
    buffer_load_dwordx4 v13, s[12:15], s25 offen lds
    ds_read_b64_tr_b16 v[192:193], v5 offset:7488
    ds_read_b64_tr_b16 v[194:195], v5 offset:11072
    v_mfma_f32_32x32x16_bf16 v[96:111], v[160:163], a[0:3], v[96:111]
    ds_read_b64_tr_b16 v[196:197], v5 offset:7552
    ds_read_b64_tr_b16 v[198:199], v5 offset:11136
    v_mfma_f32_32x32x16_bf16 v[112:127], v[164:167], a[0:3], v[112:127]
    s_add_u32 m0, s26, 63488
    s_nop 0
    buffer_load_dwordx4 v14, s[12:15], s25 offen lds
    v_mfma_f32_32x32x16_bf16 v[128:143], v[168:171], a[0:3], v[128:143]
    s_waitcnt lgkmcnt(0)
    v_mfma_f32_32x32x16_bf16 v[32:47], v[172:175], a[4:7], v[32:47]
    ds_read_b64_tr_b16 v[144:145], v5 offset:14336
    ds_read_b64_tr_b16 v[146:147], v5 offset:17920
    ds_read_b64_tr_b16 v[148:149], v5 offset:14400
    buffer_load_dwordx4 a[32:35], v2, s[8:11], s24 offen offset:0 sc1
    v_mfma_f32_32x32x16_bf16 v[48:63], v[176:179], a[4:7], v[48:63]
    ds_read_b64_tr_b16 v[150:151], v5 offset:17984
    ds_read_b64_tr_b16 v[152:153], v5 offset:14464
    ds_read_b64_tr_b16 v[154:155], v5 offset:18048
    v_mfma_f32_32x32x16_bf16 v[64:79], v[180:183], a[4:7], v[64:79]
    ds_read_b64_tr_b16 v[156:157], v5 offset:14528
    ds_read_b64_tr_b16 v[158:159], v5 offset:18112
    ds_read_b64_tr_b16 v[160:161], v5 offset:14592
    buffer_load_dwordx4 a[36:39], v2, s[8:11], s24 offen offset:1024 sc1
    v_mfma_f32_32x32x16_bf16 v[80:95], v[184:187], a[4:7], v[80:95]
    ds_read_b64_tr_b16 v[162:163], v5 offset:18176
    ds_read_b64_tr_b16 v[164:165], v5 offset:14656
    ds_read_b64_tr_b16 v[166:167], v5 offset:18240
    v_mfma_f32_32x32x16_bf16 v[96:111], v[188:191], a[4:7], v[96:111]
    ds_read_b64_tr_b16 v[168:169], v5 offset:14720
    ds_read_b64_tr_b16 v[170:171], v5 offset:18304
    buffer_load_dwordx4 a[40:43], v2, s[8:11], s24 offen offset:2048 sc1
    v_mfma_f32_32x32x16_bf16 v[112:127], v[192:195], a[4:7], v[112:127]
    v_mfma_f32_32x32x16_bf16 v[128:143], v[196:199], a[4:7], v[128:143]
    buffer_load_dwordx4 a[44:47], v2, s[8:11], s24 offen offset:3072 sc1
    s_waitcnt lgkmcnt(0)
    v_mfma_f32_32x32x16_bf16 v[32:47], v[144:147], a[8:11], v[32:47]
    ds_read_b64_tr_b16 v[172:173], v5 offset:21504
    ds_read_b64_tr_b16 v[174:175], v5 offset:25088
    ds_read_b64_tr_b16 v[176:177], v5 offset:21568
    v_mfma_f32_32x32x16_bf16 v[48:63], v[148:151], a[8:11], v[48:63]
    ds_read_b64_tr_b16 v[178:179], v5 offset:25152
    ds_read_b64_tr_b16 v[180:181], v5 offset:21632
    ds_read_b64_tr_b16 v[182:183], v5 offset:25216
    v_mfma_f32_32x32x16_bf16 v[64:79], v[152:155], a[8:11], v[64:79]
    ds_read_b64_tr_b16 v[184:185], v5 offset:21696
    ds_read_b64_tr_b16 v[186:187], v5 offset:25280
    ds_read_b64_tr_b16 v[188:189], v5 offset:21760
    v_mfma_f32_32x32x16_bf16 v[80:95], v[156:159], a[8:11], v[80:95]
    ds_read_b64_tr_b16 v[190:191], v5 offset:25344
    ds_read_b64_tr_b16 v[192:193], v5 offset:21824
    ds_read_b64_tr_b16 v[194:195], v5 offset:25408
    v_mfma_f32_32x32x16_bf16 v[96:111], v[160:163], a[8:11], v[96:111]
    ds_read_b64_tr_b16 v[196:197], v5 offset:21888
    ds_read_b64_tr_b16 v[198:199], v5 offset:25472
    v_mfma_f32_32x32x16_bf16 v[112:127], v[164:167], a[8:11], v[112:127]
    v_mfma_f32_32x32x16_bf16 v[128:143], v[168:171], a[8:11], v[128:143]
    s_add_u32 s24, s24, 4096
    s_add_u32 s25, s25, 458752
    s_waitcnt lgkmcnt(0)
    s_waitcnt vmcnt(11)
    s_barrier
    v_add_u32 v5, 28672, v3
    v_mfma_f32_32x32x16_bf16 v[32:47], v[172:175], a[12:15], v[32:47]
    s_add_u32 m0, s26, 86016
    ds_read_b64_tr_b16 v[144:145], v5 offset:0
    buffer_load_dwordx4 v8, s[12:15], s25 offen lds
    ds_read_b64_tr_b16 v[146:147], v5 offset:3584
    ds_read_b64_tr_b16 v[148:149], v5 offset:64
    v_mfma_f32_32x32x16_bf16 v[48:63], v[176:179], a[12:15], v[48:63]
    ds_read_b64_tr_b16 v[150:151], v5 offset:3648
    ds_read_b64_tr_b16 v[152:153], v5 offset:128
    ds_read_b64_tr_b16 v[154:155], v5 offset:3712
    v_mfma_f32_32x32x16_bf16 v[64:79], v[180:183], a[12:15], v[64:79]
    s_add_u32 m0, s26, 87040
    ds_read_b64_tr_b16 v[156:157], v5 offset:192
    buffer_load_dwordx4 v9, s[12:15], s25 offen lds
    ds_read_b64_tr_b16 v[158:159], v5 offset:3776
    ds_read_b64_tr_b16 v[160:161], v5 offset:256
    v_mfma_f32_32x32x16_bf16 v[80:95], v[184:187], a[12:15], v[80:95]
    ds_read_b64_tr_b16 v[162:163], v5 offset:3840
    ds_read_b64_tr_b16 v[164:165], v5 offset:320
    ds_read_b64_tr_b16 v[166:167], v5 offset:3904
    v_mfma_f32_32x32x16_bf16 v[96:111], v[188:191], a[12:15], v[96:111]
    s_add_u32 m0, s26, 88064
    ds_read_b64_tr_b16 v[168:169], v5 offset:384
    buffer_load_dwordx4 v10, s[12:15], s25 offen lds
    ds_read_b64_tr_b16 v[170:171], v5 offset:3968
    v_mfma_f32_32x32x16_bf16 v[112:127], v[192:195], a[12:15], v[112:127]
    v_mfma_f32_32x32x16_bf16 v[128:143], v[196:199], a[12:15], v[128:143]
    s_add_u32 m0, s26, 89088
    s_nop 0
    buffer_load_dwordx4 v11, s[12:15], s25 offen lds
    s_waitcnt lgkmcnt(0)
    v_mfma_f32_32x32x16_bf16 v[32:47], v[144:147], a[16:19], v[32:47]
    ds_read_b64_tr_b16 v[172:173], v5 offset:7168
    ds_read_b64_tr_b16 v[174:175], v5 offset:10752
    ds_read_b64_tr_b16 v[176:177], v5 offset:7232
    v_mfma_f32_32x32x16_bf16 v[48:63], v[148:151], a[16:19], v[48:63]
    s_add_u32 m0, s26, 90112
    ds_read_b64_tr_b16 v[178:179], v5 offset:10816
    buffer_load_dwordx4 v12, s[12:15], s25 offen lds
    ds_read_b64_tr_b16 v[180:181], v5 offset:7296
    ds_read_b64_tr_b16 v[182:183], v5 offset:10880
    v_mfma_f32_32x32x16_bf16 v[64:79], v[152:155], a[16:19], v[64:79]
    ds_read_b64_tr_b16 v[184:185], v5 offset:7360
    ds_read_b64_tr_b16 v[186:187], v5 offset:10944
    ds_read_b64_tr_b16 v[188:189], v5 offset:7424
    v_mfma_f32_32x32x16_bf16 v[80:95], v[156:159], a[16:19], v[80:95]
    s_add_u32 m0, s26, 91136
    ds_read_b64_tr_b16 v[190:191], v5 offset:11008
    buffer_load_dwordx4 v13, s[12:15], s25 offen lds
    ds_read_b64_tr_b16 v[192:193], v5 offset:7488
    ds_read_b64_tr_b16 v[194:195], v5 offset:11072
    v_mfma_f32_32x32x16_bf16 v[96:111], v[160:163], a[16:19], v[96:111]
    ds_read_b64_tr_b16 v[196:197], v5 offset:7552
    ds_read_b64_tr_b16 v[198:199], v5 offset:11136
    v_mfma_f32_32x32x16_bf16 v[112:127], v[164:167], a[16:19], v[112:127]
    s_add_u32 m0, s26, 92160
    s_nop 0
    buffer_load_dwordx4 v14, s[12:15], s25 offen lds
    v_mfma_f32_32x32x16_bf16 v[128:143], v[168:171], a[16:19], v[128:143]
    s_waitcnt lgkmcnt(0)
    v_mfma_f32_32x32x16_bf16 v[32:47], v[172:175], a[20:23], v[32:47]
    ds_read_b64_tr_b16 v[144:145], v5 offset:14336
    ds_read_b64_tr_b16 v[146:147], v5 offset:17920
    ds_read_b64_tr_b16 v[148:149], v5 offset:14400
    buffer_load_dwordx4 a[48:51], v2, s[8:11], s24 offen offset:0 sc1
    v_mfma_f32_32x32x16_bf16 v[48:63], v[176:179], a[20:23], v[48:63]
    ds_read_b64_tr_b16 v[150:151], v5 offset:17984
    ds_read_b64_tr_b16 v[152:153], v5 offset:14464
    ds_read_b64_tr_b16 v[154:155], v5 offset:18048
    v_mfma_f32_32x32x16_bf16 v[64:79], v[180:183], a[20:23], v[64:79]
    ds_read_b64_tr_b16 v[156:157], v5 offset:14528
    ds_read_b64_tr_b16 v[158:159], v5 offset:18112
    ds_read_b64_tr_b16 v[160:161], v5 offset:14592
    buffer_load_dwordx4 a[52:55], v2, s[8:11], s24 offen offset:1024 sc1
    v_mfma_f32_32x32x16_bf16 v[80:95], v[184:187], a[20:23], v[80:95]
    ds_read_b64_tr_b16 v[162:163], v5 offset:18176
    ds_read_b64_tr_b16 v[164:165], v5 offset:14656
    ds_read_b64_tr_b16 v[166:167], v5 offset:18240
    v_mfma_f32_32x32x16_bf16 v[96:111], v[188:191], a[20:23], v[96:111]
    ds_read_b64_tr_b16 v[168:169], v5 offset:14720
    ds_read_b64_tr_b16 v[170:171], v5 offset:18304
    buffer_load_dwordx4 a[56:59], v2, s[8:11], s24 offen offset:2048 sc1
    v_mfma_f32_32x32x16_bf16 v[112:127], v[192:195], a[20:23], v[112:127]
    v_mfma_f32_32x32x16_bf16 v[128:143], v[196:199], a[20:23], v[128:143]
    buffer_load_dwordx4 a[60:63], v2, s[8:11], s24 offen offset:3072 sc1
    s_waitcnt lgkmcnt(0)
    v_mfma_f32_32x32x16_bf16 v[32:47], v[144:147], a[24:27], v[32:47]
    ds_read_b64_tr_b16 v[172:173], v5 offset:21504
    ds_read_b64_tr_b16 v[174:175], v5 offset:25088
    ds_read_b64_tr_b16 v[176:177], v5 offset:21568
    v_mfma_f32_32x32x16_bf16 v[48:63], v[148:151], a[24:27], v[48:63]
    ds_read_b64_tr_b16 v[178:179], v5 offset:25152
    ds_read_b64_tr_b16 v[180:181], v5 offset:21632
    ds_read_b64_tr_b16 v[182:183], v5 offset:25216
    v_mfma_f32_32x32x16_bf16 v[64:79], v[152:155], a[24:27], v[64:79]
    ds_read_b64_tr_b16 v[184:185], v5 offset:21696
    ds_read_b64_tr_b16 v[186:187], v5 offset:25280
    ds_read_b64_tr_b16 v[188:189], v5 offset:21760
    v_mfma_f32_32x32x16_bf16 v[80:95], v[156:159], a[24:27], v[80:95]
    ds_read_b64_tr_b16 v[190:191], v5 offset:25344
    ds_read_b64_tr_b16 v[192:193], v5 offset:21824
    ds_read_b64_tr_b16 v[194:195], v5 offset:25408
    v_mfma_f32_32x32x16_bf16 v[96:111], v[160:163], a[24:27], v[96:111]
    ds_read_b64_tr_b16 v[196:197], v5 offset:21888
    ds_read_b64_tr_b16 v[198:199], v5 offset:25472
    v_mfma_f32_32x32x16_bf16 v[112:127], v[164:167], a[24:27], v[112:127]
    v_mfma_f32_32x32x16_bf16 v[128:143], v[168:171], a[24:27], v[128:143]
    s_add_u32 s24, s24, 4096
    s_add_u32 s25, s25, 458752
    s_waitcnt lgkmcnt(0)
    s_waitcnt vmcnt(11)
    s_barrier
    v_add_u32 v5, 57344, v3
    v_mfma_f32_32x32x16_bf16 v[32:47], v[172:175], a[28:31], v[32:47]
    s_add_u32 m0, s26, 0
    ds_read_b64_tr_b16 v[144:145], v5 offset:0
    buffer_load_dwordx4 v8, s[12:15], s25 offen lds
    ds_read_b64_tr_b16 v[146:147], v5 offset:3584
    ds_read_b64_tr_b16 v[148:149], v5 offset:64
    v_mfma_f32_32x32x16_bf16 v[48:63], v[176:179], a[28:31], v[48:63]
    ds_read_b64_tr_b16 v[150:151], v5 offset:3648
    ds_read_b64_tr_b16 v[152:153], v5 offset:128
    ds_read_b64_tr_b16 v[154:155], v5 offset:3712
    v_mfma_f32_32x32x16_bf16 v[64:79], v[180:183], a[28:31], v[64:79]
    s_add_u32 m0, s26, 1024
    ds_read_b64_tr_b16 v[156:157], v5 offset:192
    buffer_load_dwordx4 v9, s[12:15], s25 offen lds
    ds_read_b64_tr_b16 v[158:159], v5 offset:3776
    ds_read_b64_tr_b16 v[160:161], v5 offset:256
    v_mfma_f32_32x32x16_bf16 v[80:95], v[184:187], a[28:31], v[80:95]
    ds_read_b64_tr_b16 v[162:163], v5 offset:3840
    ds_read_b64_tr_b16 v[164:165], v5 offset:320
    ds_read_b64_tr_b16 v[166:167], v5 offset:3904
    v_mfma_f32_32x32x16_bf16 v[96:111], v[188:191], a[28:31], v[96:111]
    s_add_u32 m0, s26, 2048
    ds_read_b64_tr_b16 v[168:169], v5 offset:384
    buffer_load_dwordx4 v10, s[12:15], s25 offen lds
    ds_read_b64_tr_b16 v[170:171], v5 offset:3968
    v_mfma_f32_32x32x16_bf16 v[112:127], v[192:195], a[28:31], v[112:127]
    v_mfma_f32_32x32x16_bf16 v[128:143], v[196:199], a[28:31], v[128:143]
    s_add_u32 m0, s26, 3072
    s_nop 0
    buffer_load_dwordx4 v11, s[12:15], s25 offen lds
    s_waitcnt lgkmcnt(0)
    v_mfma_f32_32x32x16_bf16 v[32:47], v[144:147], a[32:35], v[32:47]
    ds_read_b64_tr_b16 v[172:173], v5 offset:7168
    ds_read_b64_tr_b16 v[174:175], v5 offset:10752
    ds_read_b64_tr_b16 v[176:177], v5 offset:7232
    v_mfma_f32_32x32x16_bf16 v[48:63], v[148:151], a[32:35], v[48:63]
    s_add_u32 m0, s26, 4096
    ds_read_b64_tr_b16 v[178:179], v5 offset:10816
    buffer_load_dwordx4 v12, s[12:15], s25 offen lds
    ds_read_b64_tr_b16 v[180:181], v5 offset:7296
    ds_read_b64_tr_b16 v[182:183], v5 offset:10880
    v_mfma_f32_32x32x16_bf16 v[64:79], v[152:155], a[32:35], v[64:79]
    ds_read_b64_tr_b16 v[184:185], v5 offset:7360
    ds_read_b64_tr_b16 v[186:187], v5 offset:10944
    ds_read_b64_tr_b16 v[188:189], v5 offset:7424
    v_mfma_f32_32x32x16_bf16 v[80:95], v[156:159], a[32:35], v[80:95]
    s_add_u32 m0, s26, 5120
    ds_read_b64_tr_b16 v[190:191], v5 offset:11008
    buffer_load_dwordx4 v13, s[12:15], s25 offen lds
    ds_read_b64_tr_b16 v[192:193], v5 offset:7488
    ds_read_b64_tr_b16 v[194:195], v5 offset:11072
    v_mfma_f32_32x32x16_bf16 v[96:111], v[160:163], a[32:35], v[96:111]
    ds_read_b64_tr_b16 v[196:197], v5 offset:7552
    ds_read_b64_tr_b16 v[198:199], v5 offset:11136
    v_mfma_f32_32x32x16_bf16 v[112:127], v[164:167], a[32:35], v[112:127]
    s_add_u32 m0, s26, 6144
    s_nop 0
    buffer_load_dwordx4 v14, s[12:15], s25 offen lds
    v_mfma_f32_32x32x16_bf16 v[128:143], v[168:171], a[32:35], v[128:143]
    s_waitcnt lgkmcnt(0)
    v_mfma_f32_32x32x16_bf16 v[32:47], v[172:175], a[36:39], v[32:47]
    ds_read_b64_tr_b16 v[144:145], v5 offset:14336
    ds_read_b64_tr_b16 v[146:147], v5 offset:17920
    ds_read_b64_tr_b16 v[148:149], v5 offset:14400
    buffer_load_dwordx4 a[0:3], v2, s[8:11], s24 offen offset:0 sc1
    v_mfma_f32_32x32x16_bf16 v[48:63], v[176:179], a[36:39], v[48:63]
    ds_read_b64_tr_b16 v[150:151], v5 offset:17984
    ds_read_b64_tr_b16 v[152:153], v5 offset:14464
    ds_read_b64_tr_b16 v[154:155], v5 offset:18048
    v_mfma_f32_32x32x16_bf16 v[64:79], v[180:183], a[36:39], v[64:79]
    ds_read_b64_tr_b16 v[156:157], v5 offset:14528
    ds_read_b64_tr_b16 v[158:159], v5 offset:18112
    ds_read_b64_tr_b16 v[160:161], v5 offset:14592
    buffer_load_dwordx4 a[4:7], v2, s[8:11], s24 offen offset:1024 sc1
    v_mfma_f32_32x32x16_bf16 v[80:95], v[184:187], a[36:39], v[80:95]
    ds_read_b64_tr_b16 v[162:163], v5 offset:18176
    ds_read_b64_tr_b16 v[164:165], v5 offset:14656
    ds_read_b64_tr_b16 v[166:167], v5 offset:18240
    v_mfma_f32_32x32x16_bf16 v[96:111], v[188:191], a[36:39], v[96:111]
    ds_read_b64_tr_b16 v[168:169], v5 offset:14720
    ds_read_b64_tr_b16 v[170:171], v5 offset:18304
    buffer_load_dwordx4 a[8:11], v2, s[8:11], s24 offen offset:2048 sc1
    v_mfma_f32_32x32x16_bf16 v[112:127], v[192:195], a[36:39], v[112:127]
    v_mfma_f32_32x32x16_bf16 v[128:143], v[196:199], a[36:39], v[128:143]
    buffer_load_dwordx4 a[12:15], v2, s[8:11], s24 offen offset:3072 sc1
    s_waitcnt lgkmcnt(0)
    v_mfma_f32_32x32x16_bf16 v[32:47], v[144:147], a[40:43], v[32:47]
    ds_read_b64_tr_b16 v[172:173], v5 offset:21504
    ds_read_b64_tr_b16 v[174:175], v5 offset:25088
    ds_read_b64_tr_b16 v[176:177], v5 offset:21568
    v_mfma_f32_32x32x16_bf16 v[48:63], v[148:151], a[40:43], v[48:63]
    ds_read_b64_tr_b16 v[178:179], v5 offset:25152
    ds_read_b64_tr_b16 v[180:181], v5 offset:21632
    ds_read_b64_tr_b16 v[182:183], v5 offset:25216
    v_mfma_f32_32x32x16_bf16 v[64:79], v[152:155], a[40:43], v[64:79]
    ds_read_b64_tr_b16 v[184:185], v5 offset:21696
    ds_read_b64_tr_b16 v[186:187], v5 offset:25280
    ds_read_b64_tr_b16 v[188:189], v5 offset:21760
    v_mfma_f32_32x32x16_bf16 v[80:95], v[156:159], a[40:43], v[80:95]
    ds_read_b64_tr_b16 v[190:191], v5 offset:25344
    ds_read_b64_tr_b16 v[192:193], v5 offset:21824
    ds_read_b64_tr_b16 v[194:195], v5 offset:25408
    v_mfma_f32_32x32x16_bf16 v[96:111], v[160:163], a[40:43], v[96:111]
    ds_read_b64_tr_b16 v[196:197], v5 offset:21888
    ds_read_b64_tr_b16 v[198:199], v5 offset:25472
    v_mfma_f32_32x32x16_bf16 v[112:127], v[164:167], a[40:43], v[112:127]
    v_mfma_f32_32x32x16_bf16 v[128:143], v[168:171], a[40:43], v[128:143]
    s_add_u32 s24, s24, 4096
    s_add_u32 s25, s25, 458752
    s_waitcnt lgkmcnt(0)
    s_waitcnt vmcnt(11)
    s_barrier
    v_add_u32 v5, 86016, v3
    v_mfma_f32_32x32x16_bf16 v[32:47], v[172:175], a[44:47], v[32:47]
    s_add_u32 m0, s26, 28672
    ds_read_b64_tr_b16 v[144:145], v5 offset:0
    buffer_load_dwordx4 v8, s[12:15], s25 offen lds
    ds_read_b64_tr_b16 v[146:147], v5 offset:3584
    ds_read_b64_tr_b16 v[148:149], v5 offset:64
    v_mfma_f32_32x32x16_bf16 v[48:63], v[176:179], a[44:47], v[48:63]
    ds_read_b64_tr_b16 v[150:151], v5 offset:3648
    ds_read_b64_tr_b16 v[152:153], v5 offset:128
    ds_read_b64_tr_b16 v[154:155], v5 offset:3712
    v_mfma_f32_32x32x16_bf16 v[64:79], v[180:183], a[44:47], v[64:79]
    s_add_u32 m0, s26, 29696
    ds_read_b64_tr_b16 v[156:157], v5 offset:192
    buffer_load_dwordx4 v9, s[12:15], s25 offen lds
    ds_read_b64_tr_b16 v[158:159], v5 offset:3776
    ds_read_b64_tr_b16 v[160:161], v5 offset:256
    v_mfma_f32_32x32x16_bf16 v[80:95], v[184:187], a[44:47], v[80:95]
    ds_read_b64_tr_b16 v[162:163], v5 offset:3840
    ds_read_b64_tr_b16 v[164:165], v5 offset:320
    ds_read_b64_tr_b16 v[166:167], v5 offset:3904
    v_mfma_f32_32x32x16_bf16 v[96:111], v[188:191], a[44:47], v[96:111]
    s_add_u32 m0, s26, 30720
    ds_read_b64_tr_b16 v[168:169], v5 offset:384
    buffer_load_dwordx4 v10, s[12:15], s25 offen lds
    ds_read_b64_tr_b16 v[170:171], v5 offset:3968
    v_mfma_f32_32x32x16_bf16 v[112:127], v[192:195], a[44:47], v[112:127]
    v_mfma_f32_32x32x16_bf16 v[128:143], v[196:199], a[44:47], v[128:143]
    s_add_u32 m0, s26, 31744
    s_nop 0
    buffer_load_dwordx4 v11, s[12:15], s25 offen lds
    s_waitcnt lgkmcnt(0)
    v_mfma_f32_32x32x16_bf16 v[32:47], v[144:147], a[48:51], v[32:47]
    ds_read_b64_tr_b16 v[172:173], v5 offset:7168
    ds_read_b64_tr_b16 v[174:175], v5 offset:10752
    ds_read_b64_tr_b16 v[176:177], v5 offset:7232
    v_mfma_f32_32x32x16_bf16 v[48:63], v[148:151], a[48:51], v[48:63]
    s_add_u32 m0, s26, 32768
    ds_read_b64_tr_b16 v[178:179], v5 offset:10816
    buffer_load_dwordx4 v12, s[12:15], s25 offen lds
    ds_read_b64_tr_b16 v[180:181], v5 offset:7296
    ds_read_b64_tr_b16 v[182:183], v5 offset:10880
    v_mfma_f32_32x32x16_bf16 v[64:79], v[152:155], a[48:51], v[64:79]
    ds_read_b64_tr_b16 v[184:185], v5 offset:7360
    ds_read_b64_tr_b16 v[186:187], v5 offset:10944
    ds_read_b64_tr_b16 v[188:189], v5 offset:7424
    v_mfma_f32_32x32x16_bf16 v[80:95], v[156:159], a[48:51], v[80:95]
    s_add_u32 m0, s26, 33792
    ds_read_b64_tr_b16 v[190:191], v5 offset:11008
    buffer_load_dwordx4 v13, s[12:15], s25 offen lds
    ds_read_b64_tr_b16 v[192:193], v5 offset:7488
    ds_read_b64_tr_b16 v[194:195], v5 offset:11072
    v_mfma_f32_32x32x16_bf16 v[96:111], v[160:163], a[48:51], v[96:111]
    ds_read_b64_tr_b16 v[196:197], v5 offset:7552
    ds_read_b64_tr_b16 v[198:199], v5 offset:11136
    v_mfma_f32_32x32x16_bf16 v[112:127], v[164:167], a[48:51], v[112:127]
    s_add_u32 m0, s26, 34816
    s_nop 0
    buffer_load_dwordx4 v14, s[12:15], s25 offen lds
    v_mfma_f32_32x32x16_bf16 v[128:143], v[168:171], a[48:51], v[128:143]
    s_waitcnt lgkmcnt(0)
    v_mfma_f32_32x32x16_bf16 v[32:47], v[172:175], a[52:55], v[32:47]
    ds_read_b64_tr_b16 v[144:145], v5 offset:14336
    ds_read_b64_tr_b16 v[146:147], v5 offset:17920
    ds_read_b64_tr_b16 v[148:149], v5 offset:14400
    buffer_load_dwordx4 a[16:19], v2, s[8:11], s24 offen offset:0 sc1
    v_mfma_f32_32x32x16_bf16 v[48:63], v[176:179], a[52:55], v[48:63]
    ds_read_b64_tr_b16 v[150:151], v5 offset:17984
    ds_read_b64_tr_b16 v[152:153], v5 offset:14464
    ds_read_b64_tr_b16 v[154:155], v5 offset:18048
    v_mfma_f32_32x32x16_bf16 v[64:79], v[180:183], a[52:55], v[64:79]
    ds_read_b64_tr_b16 v[156:157], v5 offset:14528
    ds_read_b64_tr_b16 v[158:159], v5 offset:18112
    ds_read_b64_tr_b16 v[160:161], v5 offset:14592
    buffer_load_dwordx4 a[20:23], v2, s[8:11], s24 offen offset:1024 sc1
    v_mfma_f32_32x32x16_bf16 v[80:95], v[184:187], a[52:55], v[80:95]
    ds_read_b64_tr_b16 v[162:163], v5 offset:18176
    ds_read_b64_tr_b16 v[164:165], v5 offset:14656
    ds_read_b64_tr_b16 v[166:167], v5 offset:18240
    v_mfma_f32_32x32x16_bf16 v[96:111], v[188:191], a[52:55], v[96:111]
    ds_read_b64_tr_b16 v[168:169], v5 offset:14720
    ds_read_b64_tr_b16 v[170:171], v5 offset:18304
    buffer_load_dwordx4 a[24:27], v2, s[8:11], s24 offen offset:2048 sc1
    v_mfma_f32_32x32x16_bf16 v[112:127], v[192:195], a[52:55], v[112:127]
    v_mfma_f32_32x32x16_bf16 v[128:143], v[196:199], a[52:55], v[128:143]
    buffer_load_dwordx4 a[28:31], v2, s[8:11], s24 offen offset:3072 sc1
    s_waitcnt lgkmcnt(0)
    v_mfma_f32_32x32x16_bf16 v[32:47], v[144:147], a[56:59], v[32:47]
    ds_read_b64_tr_b16 v[172:173], v5 offset:21504
    ds_read_b64_tr_b16 v[174:175], v5 offset:25088
    ds_read_b64_tr_b16 v[176:177], v5 offset:21568
    v_mfma_f32_32x32x16_bf16 v[48:63], v[148:151], a[56:59], v[48:63]
    ds_read_b64_tr_b16 v[178:179], v5 offset:25152
    ds_read_b64_tr_b16 v[180:181], v5 offset:21632
    ds_read_b64_tr_b16 v[182:183], v5 offset:25216
    v_mfma_f32_32x32x16_bf16 v[64:79], v[152:155], a[56:59], v[64:79]
    ds_read_b64_tr_b16 v[184:185], v5 offset:21696
    ds_read_b64_tr_b16 v[186:187], v5 offset:25280
    ds_read_b64_tr_b16 v[188:189], v5 offset:21760
    v_mfma_f32_32x32x16_bf16 v[80:95], v[156:159], a[56:59], v[80:95]
    ds_read_b64_tr_b16 v[190:191], v5 offset:25344
    ds_read_b64_tr_b16 v[192:193], v5 offset:21824
    ds_read_b64_tr_b16 v[194:195], v5 offset:25408
    v_mfma_f32_32x32x16_bf16 v[96:111], v[160:163], a[56:59], v[96:111]
    ds_read_b64_tr_b16 v[196:197], v5 offset:21888
    ds_read_b64_tr_b16 v[198:199], v5 offset:25472
    v_mfma_f32_32x32x16_bf16 v[112:127], v[164:167], a[56:59], v[112:127]
    v_mfma_f32_32x32x16_bf16 v[128:143], v[168:171], a[56:59], v[128:143]
    s_add_u32 s24, s24, 4096
    s_add_u32 s25, s25, 458752
    s_waitcnt lgkmcnt(0)
    s_waitcnt vmcnt(11)
    s_barrier
    v_add_u32 v5, 0, v3
    v_mfma_f32_32x32x16_bf16 v[32:47], v[172:175], a[60:63], v[32:47]
    s_add_u32 m0, s26, 57344
    ds_read_b64_tr_b16 v[144:145], v5 offset:0
    buffer_load_dwordx4 v8, s[12:15], s25 offen lds
    ds_read_b64_tr_b16 v[146:147], v5 offset:3584
    ds_read_b64_tr_b16 v[148:149], v5 offset:64
    v_mfma_f32_32x32x16_bf16 v[48:63], v[176:179], a[60:63], v[48:63]
    ds_read_b64_tr_b16 v[150:151], v5 offset:3648
    ds_read_b64_tr_b16 v[152:153], v5 offset:128
    ds_read_b64_tr_b16 v[154:155], v5 offset:3712
    v_mfma_f32_32x32x16_bf16 v[64:79], v[180:183], a[60:63], v[64:79]
    s_add_u32 m0, s26, 58368
    ds_read_b64_tr_b16 v[156:157], v5 offset:192
    buffer_load_dwordx4 v9, s[12:15], s25 offen lds
    ds_read_b64_tr_b16 v[158:159], v5 offset:3776
    ds_read_b64_tr_b16 v[160:161], v5 offset:256
    v_mfma_f32_32x32x16_bf16 v[80:95], v[184:187], a[60:63], v[80:95]
    ds_read_b64_tr_b16 v[162:163], v5 offset:3840
    ds_read_b64_tr_b16 v[164:165], v5 offset:320
    ds_read_b64_tr_b16 v[166:167], v5 offset:3904
    v_mfma_f32_32x32x16_bf16 v[96:111], v[188:191], a[60:63], v[96:111]
    s_add_u32 m0, s26, 59392
    ds_read_b64_tr_b16 v[168:169], v5 offset:384
    buffer_load_dwordx4 v10, s[12:15], s25 offen lds
    ds_read_b64_tr_b16 v[170:171], v5 offset:3968
    v_mfma_f32_32x32x16_bf16 v[112:127], v[192:195], a[60:63], v[112:127]
    v_mfma_f32_32x32x16_bf16 v[128:143], v[196:199], a[60:63], v[128:143]
    s_add_u32 m0, s26, 60416
    s_nop 0
    buffer_load_dwordx4 v11, s[12:15], s25 offen lds
    s_sub_u32 s27, s27, 1
    s_cmp_lg_u32 s27, 0
    s_cbranch_scc1 LOOP_39
    s_waitcnt vmcnt(0) lgkmcnt(0)
    v_add_f32 v232, v232, v233
    v_add_f32 v234, v234, v235
    v_add_f32 v236, v236, v237
    v_add_f32 v238, v238, v239
    v_add_f32 v232, v232, v234
    v_add_f32 v236, v236, v238
    v_lshlrev_b32 v16, 2, v0
    v_add_u32 v16, 114688, v16
    ds_write_b32 v16, v232
    ds_write_b32 v16, v236 offset:1024
    v_add_f32 v16, v200, v202
    v_add_f32 v16, v16, v204
    v_add_f32 v16, v16, v206
    v_add_f32 v16, v16, v208
    v_add_f32 v16, v16, v210
    v_add_f32 v16, v16, v212
    v_add_f32 v16, v16, v214
    v_add_f32 v16, v16, v216
    v_add_f32 v16, v16, v218
    v_add_f32 v16, v16, v220
    v_add_f32 v16, v16, v222
    v_add_f32 v16, v16, v224
    v_add_f32 v16, v16, v226
    v_add_f32 v16, v16, v228
    v_add_f32 v16, v16, v230
    v_mul_f32 v16, 0x3d800000, v16
    v_add_f32 v17, v201, v203
    v_add_f32 v17, v17, v205
    v_add_f32 v17, v17, v207
    v_add_f32 v17, v17, v209
    v_add_f32 v17, v17, v211
    v_add_f32 v17, v17, v213
    v_add_f32 v17, v17, v215
    v_add_f32 v17, v17, v217
    v_add_f32 v17, v17, v219
    v_add_f32 v17, v17, v221
    v_add_f32 v17, v17, v223
    v_add_f32 v17, v17, v225
    v_add_f32 v17, v17, v227
    v_add_f32 v17, v17, v229
    v_add_f32 v17, v17, v231
    v_sub_f32 v19, v200, v16
    v_mul_f32 v18, v19, v19
    v_sub_f32 v19, v202, v16
    v_fmac_f32 v18, v19, v19
    v_sub_f32 v19, v204, v16
    v_fmac_f32 v18, v19, v19
    v_sub_f32 v19, v206, v16
    v_fmac_f32 v18, v19, v19
    v_sub_f32 v19, v208, v16
    v_fmac_f32 v18, v19, v19
    v_sub_f32 v19, v210, v16
    v_fmac_f32 v18, v19, v19
    v_sub_f32 v19, v212, v16
    v_fmac_f32 v18, v19, v19
    v_sub_f32 v19, v214, v16
    v_fmac_f32 v18, v19, v19
    v_sub_f32 v19, v216, v16
    v_fmac_f32 v18, v19, v19
    v_sub_f32 v19, v218, v16
    v_fmac_f32 v18, v19, v19
    v_sub_f32 v19, v220, v16
    v_fmac_f32 v18, v19, v19
    v_sub_f32 v19, v222, v16
    v_fmac_f32 v18, v19, v19
    v_sub_f32 v19, v224, v16
    v_fmac_f32 v18, v19, v19
    v_sub_f32 v19, v226, v16
    v_fmac_f32 v18, v19, v19
    v_sub_f32 v19, v228, v16
    v_fmac_f32 v18, v19, v19
    v_sub_f32 v19, v230, v16
    v_fmac_f32 v18, v19, v19
    v_fmac_f32 v17, 0x42800000, v18
    v_mul_f32 v17, 0x3a800000, v17
    v_cvt_pk_bf16_f32 v18, v17, v16
    v_lshlrev_b32 v17, 16, v18
    v_and_b32 v16, s30, v18
    v_add_f32 v17, 0x3727c5ac, v17
    v_cvt_pk_bf16_f32 v18, v17, v17
    v_lshlrev_b32 v17, 16, v18
    v_sqrt_f32 v17, v17
    s_waitcnt lgkmcnt(0)
    s_barrier
    v_cvt_pk_bf16_f32 v18, v17, v17
    v_lshlrev_b32 v17, 16, v18
    v_rcp_f32 v18, v17
    v_lshrrev_b32 v22, 5, v1
    v_lshlrev_b32 v22, 4, v22
    v_add_u32 v22, 114688, v22
    v_mul_f32 v16, v16, v18
    v_sub_f32 v20, 0, v16
    v_mov_b32 v21, v20
    v_mov_b32 v19, v18
    s_mul_i32 s16, s23, 229376
    s_mul_i32 s17, s21, 14336
    s_add_u32 s16, s16, s17
    s_add_u32 s40, s4, s16
    s_addc_u32 s41, s5, 0
    s_add_u32 s40, s40, 34603008
    s_addc_u32 s41, s41, 0
    s_and_b32 s41, s41, 0xffff
    s_mov_b32 s42, 14336
    s_mov_b32 s43, 0x20000
    ds_read_b128 v[200:203], v22 offset:0
    ds_read_b128 v[216:219], v22 offset:1024
    ds_read_b128 v[204:207], v22 offset:32
    ds_read_b128 v[220:223], v22 offset:1056
    ds_read_b128 v[208:211], v22 offset:64
    ds_read_b128 v[224:227], v22 offset:1088
    ds_read_b128 v[212:215], v22 offset:96
    ds_read_b128 v[228:231], v22 offset:1120
    ds_read_b128 v[160:163], v22 offset:128
    ds_read_b128 v[176:179], v22 offset:1152
    ds_read_b128 v[164:167], v22 offset:160
    ds_read_b128 v[180:183], v22 offset:1184
    ds_read_b128 v[168:171], v22 offset:192
    ds_read_b128 v[184:187], v22 offset:1216
    ds_read_b128 v[172:175], v22 offset:224
    ds_read_b128 v[188:191], v22 offset:1248
    s_waitcnt lgkmcnt(8)
    v_pk_fma_f32 v[216:217], v[200:201], v[20:21], v[216:217]
    v_pk_fma_f32 v[218:219], v[202:203], v[20:21], v[218:219]
    v_pk_fma_f32 v[220:221], v[204:205], v[20:21], v[220:221]
    v_pk_fma_f32 v[222:223], v[206:207], v[20:21], v[222:223]
    v_pk_fma_f32 v[224:225], v[208:209], v[20:21], v[224:225]
    v_pk_fma_f32 v[226:227], v[210:211], v[20:21], v[226:227]
    v_pk_fma_f32 v[228:229], v[212:213], v[20:21], v[228:229]
    v_pk_fma_f32 v[230:231], v[214:215], v[20:21], v[230:231]
    v_pk_fma_f32 v[32:33], v[32:33], v[18:19], v[216:217]
    v_pk_fma_f32 v[34:35], v[34:35], v[18:19], v[218:219]
    v_pk_fma_f32 v[36:37], v[36:37], v[18:19], v[220:221]
    v_pk_fma_f32 v[38:39], v[38:39], v[18:19], v[222:223]
    v_pk_fma_f32 v[40:41], v[40:41], v[18:19], v[224:225]
    v_pk_fma_f32 v[42:43], v[42:43], v[18:19], v[226:227]
    v_pk_fma_f32 v[44:45], v[44:45], v[18:19], v[228:229]
    v_pk_fma_f32 v[46:47], v[46:47], v[18:19], v[230:231]
    v_cvt_pk_bf16_f32 v144, v32, v33
    v_cvt_pk_bf16_f32 v145, v34, v35
    v_cvt_pk_bf16_f32 v146, v36, v37
    v_cvt_pk_bf16_f32 v147, v38, v39
    v_cvt_pk_bf16_f32 v148, v40, v41
    v_cvt_pk_bf16_f32 v149, v42, v43
    v_cvt_pk_bf16_f32 v150, v44, v45
    v_cvt_pk_bf16_f32 v151, v46, v47
    v_pk_max_i16 v144, v144, 0
    v_pk_max_i16 v145, v145, 0
    v_pk_max_i16 v146, v146, 0
    v_pk_max_i16 v147, v147, 0
    v_pk_max_i16 v148, v148, 0
    v_pk_max_i16 v149, v149, 0
    v_pk_max_i16 v150, v150, 0
    v_pk_max_i16 v151, v151, 0
    s_mov_b32 s16, 0
    buffer_store_dwordx4 v[144:147], v2, s[40:43], s16 offen sc1
    buffer_store_dwordx4 v[148:151], v2, s[40:43], s16 offen offset:1024 sc1
    ds_read_b128 v[200:203], v22 offset:256
    ds_read_b128 v[216:219], v22 offset:1280
    ds_read_b128 v[204:207], v22 offset:288
    ds_read_b128 v[220:223], v22 offset:1312
    ds_read_b128 v[208:211], v22 offset:320
    ds_read_b128 v[224:227], v22 offset:1344
    ds_read_b128 v[212:215], v22 offset:352
    ds_read_b128 v[228:231], v22 offset:1376
    s_waitcnt lgkmcnt(8)
    v_pk_fma_f32 v[176:177], v[160:161], v[20:21], v[176:177]
    v_pk_fma_f32 v[178:179], v[162:163], v[20:21], v[178:179]
    v_pk_fma_f32 v[180:181], v[164:165], v[20:21], v[180:181]
    v_pk_fma_f32 v[182:183], v[166:167], v[20:21], v[182:183]
    v_pk_fma_f32 v[184:185], v[168:169], v[20:21], v[184:185]
    v_pk_fma_f32 v[186:187], v[170:171], v[20:21], v[186:187]
    v_pk_fma_f32 v[188:189], v[172:173], v[20:21], v[188:189]
    v_pk_fma_f32 v[190:191], v[174:175], v[20:21], v[190:191]
    v_pk_fma_f32 v[48:49], v[48:49], v[18:19], v[176:177]
    v_pk_fma_f32 v[50:51], v[50:51], v[18:19], v[178:179]
    v_pk_fma_f32 v[52:53], v[52:53], v[18:19], v[180:181]
    v_pk_fma_f32 v[54:55], v[54:55], v[18:19], v[182:183]
    v_pk_fma_f32 v[56:57], v[56:57], v[18:19], v[184:185]
    v_pk_fma_f32 v[58:59], v[58:59], v[18:19], v[186:187]
    v_pk_fma_f32 v[60:61], v[60:61], v[18:19], v[188:189]
    v_pk_fma_f32 v[62:63], v[62:63], v[18:19], v[190:191]
    v_cvt_pk_bf16_f32 v152, v48, v49
    v_cvt_pk_bf16_f32 v153, v50, v51
    v_cvt_pk_bf16_f32 v154, v52, v53
    v_cvt_pk_bf16_f32 v155, v54, v55
    v_cvt_pk_bf16_f32 v156, v56, v57
    v_cvt_pk_bf16_f32 v157, v58, v59
    v_cvt_pk_bf16_f32 v158, v60, v61
    v_cvt_pk_bf16_f32 v159, v62, v63
    v_pk_max_i16 v152, v152, 0
    v_pk_max_i16 v153, v153, 0
    v_pk_max_i16 v154, v154, 0
    v_pk_max_i16 v155, v155, 0
    v_pk_max_i16 v156, v156, 0
    v_pk_max_i16 v157, v157, 0
    v_pk_max_i16 v158, v158, 0
    v_pk_max_i16 v159, v159, 0
    s_mov_b32 s16, 2048
    buffer_store_dwordx4 v[152:155], v2, s[40:43], s16 offen sc1
    buffer_store_dwordx4 v[156:159], v2, s[40:43], s16 offen offset:1024 sc1
    ds_read_b128 v[160:163], v22 offset:384
    ds_read_b128 v[176:179], v22 offset:1408
    ds_read_b128 v[164:167], v22 offset:416
    ds_read_b128 v[180:183], v22 offset:1440
    ds_read_b128 v[168:171], v22 offset:448
    ds_read_b128 v[184:187], v22 offset:1472
    ds_read_b128 v[172:175], v22 offset:480
    ds_read_b128 v[188:191], v22 offset:1504
    s_waitcnt lgkmcnt(8)
    v_pk_fma_f32 v[216:217], v[200:201], v[20:21], v[216:217]
    v_pk_fma_f32 v[218:219], v[202:203], v[20:21], v[218:219]
    v_pk_fma_f32 v[220:221], v[204:205], v[20:21], v[220:221]
    v_pk_fma_f32 v[222:223], v[206:207], v[20:21], v[222:223]
    v_pk_fma_f32 v[224:225], v[208:209], v[20:21], v[224:225]
    v_pk_fma_f32 v[226:227], v[210:211], v[20:21], v[226:227]
    v_pk_fma_f32 v[228:229], v[212:213], v[20:21], v[228:229]
    v_pk_fma_f32 v[230:231], v[214:215], v[20:21], v[230:231]
    v_pk_fma_f32 v[64:65], v[64:65], v[18:19], v[216:217]
    v_pk_fma_f32 v[66:67], v[66:67], v[18:19], v[218:219]
    v_pk_fma_f32 v[68:69], v[68:69], v[18:19], v[220:221]
    v_pk_fma_f32 v[70:71], v[70:71], v[18:19], v[222:223]
    v_pk_fma_f32 v[72:73], v[72:73], v[18:19], v[224:225]
    v_pk_fma_f32 v[74:75], v[74:75], v[18:19], v[226:227]
    v_pk_fma_f32 v[76:77], v[76:77], v[18:19], v[228:229]
    v_pk_fma_f32 v[78:79], v[78:79], v[18:19], v[230:231]
    v_cvt_pk_bf16_f32 v144, v64, v65
    v_cvt_pk_bf16_f32 v145, v66, v67
    v_cvt_pk_bf16_f32 v146, v68, v69
    v_cvt_pk_bf16_f32 v147, v70, v71
    v_cvt_pk_bf16_f32 v148, v72, v73
    v_cvt_pk_bf16_f32 v149, v74, v75
    v_cvt_pk_bf16_f32 v150, v76, v77
    v_cvt_pk_bf16_f32 v151, v78, v79
    v_pk_max_i16 v144, v144, 0
    v_pk_max_i16 v145, v145, 0
    v_pk_max_i16 v146, v146, 0
    v_pk_max_i16 v147, v147, 0
    v_pk_max_i16 v148, v148, 0
    v_pk_max_i16 v149, v149, 0
    v_pk_max_i16 v150, v150, 0
    v_pk_max_i16 v151, v151, 0
    s_mov_b32 s16, 4096
    buffer_store_dwordx4 v[144:147], v2, s[40:43], s16 offen sc1
    buffer_store_dwordx4 v[148:151], v2, s[40:43], s16 offen offset:1024 sc1
    ds_read_b128 v[200:203], v22 offset:512
    ds_read_b128 v[216:219], v22 offset:1536
    ds_read_b128 v[204:207], v22 offset:544
    ds_read_b128 v[220:223], v22 offset:1568
    ds_read_b128 v[208:211], v22 offset:576
    ds_read_b128 v[224:227], v22 offset:1600
    ds_read_b128 v[212:215], v22 offset:608
    ds_read_b128 v[228:231], v22 offset:1632
    s_waitcnt lgkmcnt(8)
    v_pk_fma_f32 v[176:177], v[160:161], v[20:21], v[176:177]
    v_pk_fma_f32 v[178:179], v[162:163], v[20:21], v[178:179]
    v_pk_fma_f32 v[180:181], v[164:165], v[20:21], v[180:181]
    v_pk_fma_f32 v[182:183], v[166:167], v[20:21], v[182:183]
    v_pk_fma_f32 v[184:185], v[168:169], v[20:21], v[184:185]
    v_pk_fma_f32 v[186:187], v[170:171], v[20:21], v[186:187]
    v_pk_fma_f32 v[188:189], v[172:173], v[20:21], v[188:189]
    v_pk_fma_f32 v[190:191], v[174:175], v[20:21], v[190:191]
    v_pk_fma_f32 v[80:81], v[80:81], v[18:19], v[176:177]
    v_pk_fma_f32 v[82:83], v[82:83], v[18:19], v[178:179]
    v_pk_fma_f32 v[84:85], v[84:85], v[18:19], v[180:181]
    v_pk_fma_f32 v[86:87], v[86:87], v[18:19], v[182:183]
    v_pk_fma_f32 v[88:89], v[88:89], v[18:19], v[184:185]
    v_pk_fma_f32 v[90:91], v[90:91], v[18:19], v[186:187]
    v_pk_fma_f32 v[92:93], v[92:93], v[18:19], v[188:189]
    v_pk_fma_f32 v[94:95], v[94:95], v[18:19], v[190:191]
    v_cvt_pk_bf16_f32 v152, v80, v81
    v_cvt_pk_bf16_f32 v153, v82, v83
    v_cvt_pk_bf16_f32 v154, v84, v85
    v_cvt_pk_bf16_f32 v155, v86, v87
    v_cvt_pk_bf16_f32 v156, v88, v89
    v_cvt_pk_bf16_f32 v157, v90, v91
    v_cvt_pk_bf16_f32 v158, v92, v93
    v_cvt_pk_bf16_f32 v159, v94, v95
    v_pk_max_i16 v152, v152, 0
    v_pk_max_i16 v153, v153, 0
    v_pk_max_i16 v154, v154, 0
    v_pk_max_i16 v155, v155, 0
    v_pk_max_i16 v156, v156, 0
    v_pk_max_i16 v157, v157, 0
    v_pk_max_i16 v158, v158, 0
    v_pk_max_i16 v159, v159, 0
    s_mov_b32 s16, 6144
    buffer_store_dwordx4 v[152:155], v2, s[40:43], s16 offen sc1
    buffer_store_dwordx4 v[156:159], v2, s[40:43], s16 offen offset:1024 sc1
    ds_read_b128 v[160:163], v22 offset:640
    ds_read_b128 v[176:179], v22 offset:1664
    ds_read_b128 v[164:167], v22 offset:672
    ds_read_b128 v[180:183], v22 offset:1696
    ds_read_b128 v[168:171], v22 offset:704
    ds_read_b128 v[184:187], v22 offset:1728
    ds_read_b128 v[172:175], v22 offset:736
    ds_read_b128 v[188:191], v22 offset:1760
    s_waitcnt lgkmcnt(8)
    v_pk_fma_f32 v[216:217], v[200:201], v[20:21], v[216:217]
    v_pk_fma_f32 v[218:219], v[202:203], v[20:21], v[218:219]
    v_pk_fma_f32 v[220:221], v[204:205], v[20:21], v[220:221]
    v_pk_fma_f32 v[222:223], v[206:207], v[20:21], v[222:223]
    v_pk_fma_f32 v[224:225], v[208:209], v[20:21], v[224:225]
    v_pk_fma_f32 v[226:227], v[210:211], v[20:21], v[226:227]
    v_pk_fma_f32 v[228:229], v[212:213], v[20:21], v[228:229]
    v_pk_fma_f32 v[230:231], v[214:215], v[20:21], v[230:231]
    v_pk_fma_f32 v[96:97], v[96:97], v[18:19], v[216:217]
    v_pk_fma_f32 v[98:99], v[98:99], v[18:19], v[218:219]
    v_pk_fma_f32 v[100:101], v[100:101], v[18:19], v[220:221]
    v_pk_fma_f32 v[102:103], v[102:103], v[18:19], v[222:223]
    v_pk_fma_f32 v[104:105], v[104:105], v[18:19], v[224:225]
    v_pk_fma_f32 v[106:107], v[106:107], v[18:19], v[226:227]
    v_pk_fma_f32 v[108:109], v[108:109], v[18:19], v[228:229]
    v_pk_fma_f32 v[110:111], v[110:111], v[18:19], v[230:231]
    v_cvt_pk_bf16_f32 v144, v96, v97
    v_cvt_pk_bf16_f32 v145, v98, v99
    v_cvt_pk_bf16_f32 v146, v100, v101
    v_cvt_pk_bf16_f32 v147, v102, v103
    v_cvt_pk_bf16_f32 v148, v104, v105
    v_cvt_pk_bf16_f32 v149, v106, v107
    v_cvt_pk_bf16_f32 v150, v108, v109
    v_cvt_pk_bf16_f32 v151, v110, v111
    v_pk_max_i16 v144, v144, 0
    v_pk_max_i16 v145, v145, 0
    v_pk_max_i16 v146, v146, 0
    v_pk_max_i16 v147, v147, 0
    v_pk_max_i16 v148, v148, 0
    v_pk_max_i16 v149, v149, 0
    v_pk_max_i16 v150, v150, 0
    v_pk_max_i16 v151, v151, 0
    s_mov_b32 s16, 8192
    buffer_store_dwordx4 v[144:147], v2, s[40:43], s16 offen sc1
    buffer_store_dwordx4 v[148:151], v2, s[40:43], s16 offen offset:1024 sc1
    ds_read_b128 v[200:203], v22 offset:768
    ds_read_b128 v[216:219], v22 offset:1792
    ds_read_b128 v[204:207], v22 offset:800
    ds_read_b128 v[220:223], v22 offset:1824
    ds_read_b128 v[208:211], v22 offset:832
    ds_read_b128 v[224:227], v22 offset:1856
    ds_read_b128 v[212:215], v22 offset:864
    ds_read_b128 v[228:231], v22 offset:1888
    s_waitcnt lgkmcnt(8)
    v_pk_fma_f32 v[176:177], v[160:161], v[20:21], v[176:177]
    v_pk_fma_f32 v[178:179], v[162:163], v[20:21], v[178:179]
    v_pk_fma_f32 v[180:181], v[164:165], v[20:21], v[180:181]
    v_pk_fma_f32 v[182:183], v[166:167], v[20:21], v[182:183]
    v_pk_fma_f32 v[184:185], v[168:169], v[20:21], v[184:185]
    v_pk_fma_f32 v[186:187], v[170:171], v[20:21], v[186:187]
    v_pk_fma_f32 v[188:189], v[172:173], v[20:21], v[188:189]
    v_pk_fma_f32 v[190:191], v[174:175], v[20:21], v[190:191]
    v_pk_fma_f32 v[112:113], v[112:113], v[18:19], v[176:177]
    v_pk_fma_f32 v[114:115], v[114:115], v[18:19], v[178:179]
    v_pk_fma_f32 v[116:117], v[116:117], v[18:19], v[180:181]
    v_pk_fma_f32 v[118:119], v[118:119], v[18:19], v[182:183]
    v_pk_fma_f32 v[120:121], v[120:121], v[18:19], v[184:185]
    v_pk_fma_f32 v[122:123], v[122:123], v[18:19], v[186:187]
    v_pk_fma_f32 v[124:125], v[124:125], v[18:19], v[188:189]
    v_pk_fma_f32 v[126:127], v[126:127], v[18:19], v[190:191]
    v_cvt_pk_bf16_f32 v152, v112, v113
    v_cvt_pk_bf16_f32 v153, v114, v115
    v_cvt_pk_bf16_f32 v154, v116, v117
    v_cvt_pk_bf16_f32 v155, v118, v119
    v_cvt_pk_bf16_f32 v156, v120, v121
    v_cvt_pk_bf16_f32 v157, v122, v123
    v_cvt_pk_bf16_f32 v158, v124, v125
    v_cvt_pk_bf16_f32 v159, v126, v127
    v_pk_max_i16 v152, v152, 0
    v_pk_max_i16 v153, v153, 0
    v_pk_max_i16 v154, v154, 0
    v_pk_max_i16 v155, v155, 0
    v_pk_max_i16 v156, v156, 0
    v_pk_max_i16 v157, v157, 0
    v_pk_max_i16 v158, v158, 0
    v_pk_max_i16 v159, v159, 0
    s_mov_b32 s16, 10240
    buffer_store_dwordx4 v[152:155], v2, s[40:43], s16 offen sc1
    buffer_store_dwordx4 v[156:159], v2, s[40:43], s16 offen offset:1024 sc1
    s_waitcnt lgkmcnt(0)
    v_pk_fma_f32 v[216:217], v[200:201], v[20:21], v[216:217]
    v_pk_fma_f32 v[218:219], v[202:203], v[20:21], v[218:219]
    v_pk_fma_f32 v[220:221], v[204:205], v[20:21], v[220:221]
    v_pk_fma_f32 v[222:223], v[206:207], v[20:21], v[222:223]
    v_pk_fma_f32 v[224:225], v[208:209], v[20:21], v[224:225]
    v_pk_fma_f32 v[226:227], v[210:211], v[20:21], v[226:227]
    v_pk_fma_f32 v[228:229], v[212:213], v[20:21], v[228:229]
    v_pk_fma_f32 v[230:231], v[214:215], v[20:21], v[230:231]
    v_pk_fma_f32 v[128:129], v[128:129], v[18:19], v[216:217]
    v_pk_fma_f32 v[130:131], v[130:131], v[18:19], v[218:219]
    v_pk_fma_f32 v[132:133], v[132:133], v[18:19], v[220:221]
    v_pk_fma_f32 v[134:135], v[134:135], v[18:19], v[222:223]
    v_pk_fma_f32 v[136:137], v[136:137], v[18:19], v[224:225]
    v_pk_fma_f32 v[138:139], v[138:139], v[18:19], v[226:227]
    v_pk_fma_f32 v[140:141], v[140:141], v[18:19], v[228:229]
    v_pk_fma_f32 v[142:143], v[142:143], v[18:19], v[230:231]
    v_cvt_pk_bf16_f32 v144, v128, v129
    v_cvt_pk_bf16_f32 v145, v130, v131
    v_cvt_pk_bf16_f32 v146, v132, v133
    v_cvt_pk_bf16_f32 v147, v134, v135
    v_cvt_pk_bf16_f32 v148, v136, v137
    v_cvt_pk_bf16_f32 v149, v138, v139
    v_cvt_pk_bf16_f32 v150, v140, v141
    v_cvt_pk_bf16_f32 v151, v142, v143
    v_pk_max_i16 v144, v144, 0
    v_pk_max_i16 v145, v145, 0
    v_pk_max_i16 v146, v146, 0
    v_pk_max_i16 v147, v147, 0
    v_pk_max_i16 v148, v148, 0
    v_pk_max_i16 v149, v149, 0
    v_pk_max_i16 v150, v150, 0
    v_pk_max_i16 v151, v151, 0
    s_mov_b32 s16, 12288
    buffer_store_dwordx4 v[144:147], v2, s[40:43], s16 offen sc1
    buffer_store_dwordx4 v[148:151], v2, s[40:43], s16 offen offset:1024 sc1
    s_mov_b64 exec, -1
    s_waitcnt vmcnt(0)
    s_barrier
    s_cmp_lg_u32 s22, 0
    s_cbranch_scc1 NOSIG_46
    s_add_u32 s84, s4, 720896
    s_addc_u32 s85, s5, 0
    s_and_b32 s85, s85, 0xffff
    s_mov_b32 s86, 131072
    s_mov_b32 s87, 0x20000
    s_lshl_b32 s88, s20, 7
    s_add_u32 s88, s88, 8192
    s_lshl_b32 s89, s21, 2
    s_add_u32 s88, s88, s89
    s_mov_b64 exec, 1
    v_mov_b32 v254, 1
    v_mov_b32 v255, s88
    buffer_store_dword v254, v255, s[84:87], 0 offen sc1
    s_mov_b64 exec, -1
NOSIG_46:
PHF2_19:
    s_mov_b64 s[6:7], s[100:101]
    s_load_dwordx2 s[34:35], s[0:1], 64
    v_lshrrev_b32 v16, 6, v0
    v_and_b32 v1, 63, v0
    v_readfirstlane_b32 s22, v16
    s_and_b32 s16, s2, 7
    s_lshr_b32 s17, s2, 3
    s_and_b32 s36, s16, 1
    s_lshr_b32 s18, s16, 2
    s_lshl_b32 s18, s18, 3
    s_lshr_b32 s19, s17, 2
    s_add_u32 s20, s18, s19
    s_bfe_u32 s18, s16, 0x10001
    s_lshl_b32 s18, s18, 2
    s_and_b32 s19, s17, 3
    s_add_u32 s21, s18, s19
    s_lshl_b32 s23, s20, 2
    s_add_u32 s23, s23, s22
    s_mul_i32 s16, s23, 229376
    v_lshlrev_b32 v2, 4, v1
    s_mul_i32 s18, s36, 114688
    s_add_u32 s16, s16, s18
    v_lshrrev_b32 v18, 3, v1
    v_bfe_u32 v19, v1, 4, 1
    v_lshlrev_b32 v19, 2, v19
    v_and_b32 v17, 7, v1
    v_xor_b32 v17, v17, v19
    v_lshlrev_b32 v17, 4, v17
    v_mul_u32_u24 v18, 2048, v18
    v_add_u32 v17, v17, v18
    s_mul_i32 s17, s22, 32768
    s_lshl_b32 s18, s21, 8
    s_add_u32 s17, s17, s18
    v_add_u32 v17, s17, v17
    s_mul_i32 s26, s22, 2048
    v_mov_b32 v8, v17
    v_add_u32 v9, 16384, v17
    v_add_u32 v10, 128, v17
    v_add_u32 v11, 16512, v17
    s_add_u32 s8, s4, s16
    s_addc_u32 s9, s5, 0
    s_add_u32 s8, s8, 34603008
    s_addc_u32 s9, s9, 0
    s_and_b32 s9, s9, 0xffff
    s_mov_b32 s10, 114688
    s_mov_b32 s11, 0x20000
    s_mul_i32 s18, s36, 3670016
    s_add_u32 s12, s6, s18
    s_addc_u32 s13, s7, 0
    s_and_b32 s13, s13, 0xffff
    s_mov_b32 s14, 3670016
    s_mov_b32 s15, 0x20000
    s_mov_b32 s24, 0
    s_mov_b32 s25, 0
    s_add_u32 m0, s26, 0
    s_nop 0
    buffer_load_dwordx4 v8, s[12:15], s25 offen lds
    s_add_u32 m0, s26, 1024
    s_nop 0
    buffer_load_dwordx4 v9, s[12:15], s25 offen lds
    s_add_u32 m0, s26, 8192
    s_nop 0
    buffer_load_dwordx4 v10, s[12:15], s25 offen lds
    s_add_u32 m0, s26, 9216
    s_nop 0
    buffer_load_dwordx4 v11, s[12:15], s25 offen lds
    s_add_u32 s25, s25, 131072
    s_add_u32 m0, s26, 16384
    s_nop 0
    buffer_load_dwordx4 v8, s[12:15], s25 offen lds
    s_add_u32 m0, s26, 17408
    s_nop 0
    buffer_load_dwordx4 v9, s[12:15], s25 offen lds
    s_add_u32 m0, s26, 24576
    s_nop 0
    buffer_load_dwordx4 v10, s[12:15], s25 offen lds
    s_add_u32 m0, s26, 25600
    s_nop 0
    buffer_load_dwordx4 v11, s[12:15], s25 offen lds
    s_add_u32 s25, s25, 131072
    s_cmp_lg_u32 s22, 0
    s_cbranch_scc1 NOWAIT_50
    s_add_u32 s84, s4, 720896
    s_addc_u32 s85, s5, 0
    s_and_b32 s85, s85, 0xffff
    s_mov_b32 s86, 131072
    s_mov_b32 s87, 0x20000
    v_and_b32 v254, 63, v0
    v_lshlrev_b32 v254, 2, v254
    s_lshl_b32 s88, s20, 7
    s_add_u32 s88, s88, 8192
    s_lshl_b32 s89, s36, 5
    s_add_u32 s88, s88, s89
    s_mov_b32 exec_lo, 0xff
    s_mov_b32 exec_hi, 0x0
    s_mov_b32 s89, 0x8000
WLP_51:
    buffer_load_dword v255, v254, s[84:87], s88 offen sc1
    s_waitcnt vmcnt(0)
    v_cmp_ne_u32 vcc, 1, v255
    s_sub_u32 s89, s89, 1
    s_cmp_eq_u32 s89, 0
    s_cbranch_scc1 WDN_52
    s_nop 1
    s_cmp_eq_u64 vcc, 0
    s_cbranch_scc0 WLP_51
WDN_52:
    s_mov_b64 exec, -1
NOWAIT_50:
    s_barrier
    buffer_load_dwordx4 a[0:3], v2, s[8:11], s24 offen offset:0 sc1
    buffer_load_dwordx4 a[4:7], v2, s[8:11], s24 offen offset:1024 sc1
    buffer_load_dwordx4 a[8:11], v2, s[8:11], s24 offen offset:2048 sc1
    buffer_load_dwordx4 a[12:15], v2, s[8:11], s24 offen offset:3072 sc1
    s_add_u32 s24, s24, 4096
    buffer_load_dwordx4 a[16:19], v2, s[8:11], s24 offen offset:0 sc1
    buffer_load_dwordx4 a[20:23], v2, s[8:11], s24 offen offset:1024 sc1
    buffer_load_dwordx4 a[24:27], v2, s[8:11], s24 offen offset:2048 sc1
    buffer_load_dwordx4 a[28:31], v2, s[8:11], s24 offen offset:3072 sc1
    s_add_u32 s24, s24, 4096
    s_add_u32 m0, s26, 32768
    s_nop 0
    buffer_load_dwordx4 v8, s[12:15], s25 offen lds
    s_add_u32 m0, s26, 33792
    s_nop 0
    buffer_load_dwordx4 v9, s[12:15], s25 offen lds
    s_add_u32 m0, s26, 40960
    s_nop 0
    buffer_load_dwordx4 v10, s[12:15], s25 offen lds
    v_lshrrev_b32 v18, 5, v1
    v_lshlrev_b32 v18, 2, v18
    v_bfe_u32 v19, v1, 2, 2
    v_add_u32 v18, v18, v19
    v_lshlrev_b32 v18, 7, v18
    v_bfe_u32 v19, v1, 4, 1
    v_lshlrev_b32 v19, 1, v19
    v_bfe_u32 v20, v1, 1, 1
    v_add_u32 v19, v19, v20
    v_bfe_u32 v20, v1, 3, 1
    v_lshlrev_b32 v20, 2, v20
    v_xor_b32 v19, v19, v20
    v_lshlrev_b32 v19, 4, v19
    v_add_u32 v18, v18, v19
    v_and_b32 v20, 1, v1
    v_lshlrev_b32 v20, 3, v20
    v_add_u32 v3, v18, v20
    v_xor_b32 v4, 64, v3
    v_mov_b32 v32, 0
    v_mov_b32 v33, 0
    v_mov_b32 v34, 0
    v_mov_b32 v35, 0
    v_mov_b32 v36, 0
    v_mov_b32 v37, 0
    v_mov_b32 v38, 0
    v_mov_b32 v39, 0
    v_mov_b32 v40, 0
    v_mov_b32 v41, 0
    v_mov_b32 v42, 0
    v_mov_b32 v43, 0
    v_mov_b32 v44, 0
    v_mov_b32 v45, 0
    v_mov_b32 v46, 0
    v_mov_b32 v47, 0
    v_mov_b32 v48, 0
    v_mov_b32 v49, 0
    v_mov_b32 v50, 0
    v_mov_b32 v51, 0
    v_mov_b32 v52, 0
    v_mov_b32 v53, 0
    v_mov_b32 v54, 0
    v_mov_b32 v55, 0
    v_mov_b32 v56, 0
    v_mov_b32 v57, 0
    v_mov_b32 v58, 0
    v_mov_b32 v59, 0
    v_mov_b32 v60, 0
    v_mov_b32 v61, 0
    v_mov_b32 v62, 0
    v_mov_b32 v63, 0
    v_mov_b32 v64, 0
    v_mov_b32 v65, 0
    v_mov_b32 v66, 0
    v_mov_b32 v67, 0
    v_mov_b32 v68, 0
    v_mov_b32 v69, 0
    v_mov_b32 v70, 0
    v_mov_b32 v71, 0
    v_mov_b32 v72, 0
    v_mov_b32 v73, 0
    v_mov_b32 v74, 0
    v_mov_b32 v75, 0
    v_mov_b32 v76, 0
    v_mov_b32 v77, 0
    v_mov_b32 v78, 0
    v_mov_b32 v79, 0
    v_mov_b32 v80, 0
    v_mov_b32 v81, 0
    v_mov_b32 v82, 0
    v_mov_b32 v83, 0
    v_mov_b32 v84, 0
    v_mov_b32 v85, 0
    v_mov_b32 v86, 0
    v_mov_b32 v87, 0
    v_mov_b32 v88, 0
    v_mov_b32 v89, 0
    v_mov_b32 v90, 0
    v_mov_b32 v91, 0
    v_mov_b32 v92, 0
    v_mov_b32 v93, 0
    v_mov_b32 v94, 0
    v_mov_b32 v95, 0
    s_mov_b32 s30, 0xffff0000
    v_add_u32 v5, 0, v3
    v_add_u32 v6, 0, v4
    s_mov_b32 s27, 7
    s_waitcnt vmcnt(7)
    s_barrier
    ds_read_b64_tr_b16 v[96:97], v5 offset:0
    ds_read_b64_tr_b16 v[98:99], v5 offset:1024
    ds_read_b64_tr_b16 v[100:101], v6 offset:0
    ds_read_b64_tr_b16 v[102:103], v6 offset:1024
    ds_read_b64_tr_b16 v[104:105], v5 offset:8192
    ds_read_b64_tr_b16 v[106:107], v5 offset:9216
    ds_read_b64_tr_b16 v[108:109], v6 offset:8192
    ds_read_b64_tr_b16 v[110:111], v6 offset:9216
LOOP_48:
    s_cmp_lg_u32 s27, 1
    s_cbranch_scc1 NOEPI_49
    s_lshl_b32 s37, s21, 1
    s_add_u32 s37, s37, s36
    s_lshl_b32 s16, s23, 16
    s_lshl_b32 s17, s37, 12
    s_add_u32 s16, s16, s17
    s_add_u32 s40, s4, s16
    s_addc_u32 s41, s5, 0
    s_add_u32 s40, s40, 26214400
    s_addc_u32 s41, s41, 0
    s_and_b32 s41, s41, 0xffff
    s_mov_b32 s42, 4096
    s_mov_b32 s43, 0x20000
    buffer_load_dwordx4 v[128:131], v2, s[40:43], 0 offen offset:0 sc1
    buffer_load_dwordx4 v[132:135], v2, s[40:43], 0 offen offset:1024 sc1
    buffer_load_dwordx4 v[136:139], v2, s[40:43], 0 offen offset:2048 sc1
    buffer_load_dwordx4 v[140:143], v2, s[40:43], 0 offen offset:3072 sc1
    s_mov_b32 s44, s4
    s_and_b32 s45, s5, 0xffff
    s_mov_b32 s46, 24576
    s_mov_b32 s47, 0x20000
    v_and_b32 v24, 63, v0
    v_lshlrev_b32 v24, 2, v24
    s_lshl_b32 s16, s37, 8
    s_add_u32 s16, s16, 20480
    buffer_load_dword v144, v24, s[44:47], s16 offen sc1
NOEPI_49:
    s_waitcnt lgkmcnt(0)
    v_mfma_f32_32x32x16_bf16 v[32:47], v[96:99], a[0:3], v[32:47]
    ds_read_b64_tr_b16 v[112:113], v5 offset:2048
    ds_read_b64_tr_b16 v[114:115], v5 offset:3072
    ds_read_b64_tr_b16 v[116:117], v6 offset:2048
    v_mfma_f32_32x32x16_bf16 v[48:63], v[100:103], a[0:3], v[48:63]
    s_add_u32 m0, s26, 41984
    ds_read_b64_tr_b16 v[118:119], v6 offset:3072
    buffer_load_dwordx4 v11, s[12:15], s25 offen lds
    ds_read_b64_tr_b16 v[120:121], v5 offset:10240
    ds_read_b64_tr_b16 v[122:123], v5 offset:11264
    v_mfma_f32_32x32x16_bf16 v[64:79], v[104:107], a[0:3], v[64:79]
    ds_read_b64_tr_b16 v[124:125], v6 offset:10240
    ds_read_b64_tr_b16 v[126:127], v6 offset:11264
    v_mfma_f32_32x32x16_bf16 v[80:95], v[108:111], a[0:3], v[80:95]
    buffer_load_dwordx4 a[32:35], v2, s[8:11], s24 offen offset:0 sc1
    s_waitcnt lgkmcnt(0)
    v_mfma_f32_32x32x16_bf16 v[32:47], v[112:115], a[4:7], v[32:47]
    ds_read_b64_tr_b16 v[96:97], v5 offset:4096
    ds_read_b64_tr_b16 v[98:99], v5 offset:5120
    ds_read_b64_tr_b16 v[100:101], v6 offset:4096
    buffer_load_dwordx4 a[36:39], v2, s[8:11], s24 offen offset:1024 sc1
    v_mfma_f32_32x32x16_bf16 v[48:63], v[116:119], a[4:7], v[48:63]
    ds_read_b64_tr_b16 v[102:103], v6 offset:5120
    ds_read_b64_tr_b16 v[104:105], v5 offset:12288
    ds_read_b64_tr_b16 v[106:107], v5 offset:13312
    v_mfma_f32_32x32x16_bf16 v[64:79], v[120:123], a[4:7], v[64:79]
    ds_read_b64_tr_b16 v[108:109], v6 offset:12288
    ds_read_b64_tr_b16 v[110:111], v6 offset:13312
    buffer_load_dwordx4 a[40:43], v2, s[8:11], s24 offen offset:2048 sc1
    v_mfma_f32_32x32x16_bf16 v[80:95], v[124:127], a[4:7], v[80:95]
    buffer_load_dwordx4 a[44:47], v2, s[8:11], s24 offen offset:3072 sc1
    s_waitcnt lgkmcnt(0)
    v_mfma_f32_32x32x16_bf16 v[32:47], v[96:99], a[8:11], v[32:47]
    ds_read_b64_tr_b16 v[112:113], v5 offset:6144
    ds_read_b64_tr_b16 v[114:115], v5 offset:7168
    ds_read_b64_tr_b16 v[116:117], v6 offset:6144
    v_mfma_f32_32x32x16_bf16 v[48:63], v[100:103], a[8:11], v[48:63]
    ds_read_b64_tr_b16 v[118:119], v6 offset:7168
    ds_read_b64_tr_b16 v[120:121], v5 offset:14336
    ds_read_b64_tr_b16 v[122:123], v5 offset:15360
    v_mfma_f32_32x32x16_bf16 v[64:79], v[104:107], a[8:11], v[64:79]
    ds_read_b64_tr_b16 v[124:125], v6 offset:14336
    ds_read_b64_tr_b16 v[126:127], v6 offset:15360
    v_mfma_f32_32x32x16_bf16 v[80:95], v[108:111], a[8:11], v[80:95]
    s_add_u32 s24, s24, 4096
    s_add_u32 s25, s25, 131072
    s_waitcnt lgkmcnt(0)
    s_waitcnt vmcnt(8)
    s_barrier
    v_add_u32 v5, 16384, v3
    v_add_u32 v6, 16384, v4
    v_mfma_f32_32x32x16_bf16 v[32:47], v[112:115], a[12:15], v[32:47]
    s_add_u32 m0, s26, 49152
    ds_read_b64_tr_b16 v[96:97], v5 offset:0
    buffer_load_dwordx4 v8, s[12:15], s25 offen lds
    ds_read_b64_tr_b16 v[98:99], v5 offset:1024
    ds_read_b64_tr_b16 v[100:101], v6 offset:0
    v_mfma_f32_32x32x16_bf16 v[48:63], v[116:119], a[12:15], v[48:63]
    ds_read_b64_tr_b16 v[102:103], v6 offset:1024
    ds_read_b64_tr_b16 v[104:105], v5 offset:8192
    ds_read_b64_tr_b16 v[106:107], v5 offset:9216
    v_mfma_f32_32x32x16_bf16 v[64:79], v[120:123], a[12:15], v[64:79]
    s_add_u32 m0, s26, 50176
    ds_read_b64_tr_b16 v[108:109], v6 offset:8192
    buffer_load_dwordx4 v9, s[12:15], s25 offen lds
    ds_read_b64_tr_b16 v[110:111], v6 offset:9216
    v_mfma_f32_32x32x16_bf16 v[80:95], v[124:127], a[12:15], v[80:95]
    s_add_u32 m0, s26, 57344
    s_nop 0
    buffer_load_dwordx4 v10, s[12:15], s25 offen lds
    s_waitcnt lgkmcnt(0)
    v_mfma_f32_32x32x16_bf16 v[32:47], v[96:99], a[16:19], v[32:47]
    ds_read_b64_tr_b16 v[112:113], v5 offset:2048
    ds_read_b64_tr_b16 v[114:115], v5 offset:3072
    ds_read_b64_tr_b16 v[116:117], v6 offset:2048
    v_mfma_f32_32x32x16_bf16 v[48:63], v[100:103], a[16:19], v[48:63]
    s_add_u32 m0, s26, 58368
    ds_read_b64_tr_b16 v[118:119], v6 offset:3072
    buffer_load_dwordx4 v11, s[12:15], s25 offen lds
    ds_read_b64_tr_b16 v[120:121], v5 offset:10240
    ds_read_b64_tr_b16 v[122:123], v5 offset:11264
    v_mfma_f32_32x32x16_bf16 v[64:79], v[104:107], a[16:19], v[64:79]
    ds_read_b64_tr_b16 v[124:125], v6 offset:10240
    ds_read_b64_tr_b16 v[126:127], v6 offset:11264
    v_mfma_f32_32x32x16_bf16 v[80:95], v[108:111], a[16:19], v[80:95]
    buffer_load_dwordx4 a[48:51], v2, s[8:11], s24 offen offset:0 sc1
    s_waitcnt lgkmcnt(0)
    v_mfma_f32_32x32x16_bf16 v[32:47], v[112:115], a[20:23], v[32:47]
    ds_read_b64_tr_b16 v[96:97], v5 offset:4096
    ds_read_b64_tr_b16 v[98:99], v5 offset:5120
    ds_read_b64_tr_b16 v[100:101], v6 offset:4096
    buffer_load_dwordx4 a[52:55], v2, s[8:11], s24 offen offset:1024 sc1
    v_mfma_f32_32x32x16_bf16 v[48:63], v[116:119], a[20:23], v[48:63]
    ds_read_b64_tr_b16 v[102:103], v6 offset:5120
    ds_read_b64_tr_b16 v[104:105], v5 offset:12288
    ds_read_b64_tr_b16 v[106:107], v5 offset:13312
    v_mfma_f32_32x32x16_bf16 v[64:79], v[120:123], a[20:23], v[64:79]
    ds_read_b64_tr_b16 v[108:109], v6 offset:12288
    ds_read_b64_tr_b16 v[110:111], v6 offset:13312
    buffer_load_dwordx4 a[56:59], v2, s[8:11], s24 offen offset:2048 sc1
    v_mfma_f32_32x32x16_bf16 v[80:95], v[124:127], a[20:23], v[80:95]
    buffer_load_dwordx4 a[60:63], v2, s[8:11], s24 offen offset:3072 sc1
    s_waitcnt lgkmcnt(0)
    v_mfma_f32_32x32x16_bf16 v[32:47], v[96:99], a[24:27], v[32:47]
    ds_read_b64_tr_b16 v[112:113], v5 offset:6144
    ds_read_b64_tr_b16 v[114:115], v5 offset:7168
    ds_read_b64_tr_b16 v[116:117], v6 offset:6144
    v_mfma_f32_32x32x16_bf16 v[48:63], v[100:103], a[24:27], v[48:63]
    ds_read_b64_tr_b16 v[118:119], v6 offset:7168
    ds_read_b64_tr_b16 v[120:121], v5 offset:14336
    ds_read_b64_tr_b16 v[122:123], v5 offset:15360
    v_mfma_f32_32x32x16_bf16 v[64:79], v[104:107], a[24:27], v[64:79]
    ds_read_b64_tr_b16 v[124:125], v6 offset:14336
    ds_read_b64_tr_b16 v[126:127], v6 offset:15360
    v_mfma_f32_32x32x16_bf16 v[80:95], v[108:111], a[24:27], v[80:95]
    s_add_u32 s24, s24, 4096
    s_add_u32 s25, s25, 131072
    s_waitcnt lgkmcnt(0)
    s_waitcnt vmcnt(8)
    s_barrier
    v_add_u32 v5, 32768, v3
    v_add_u32 v6, 32768, v4
    v_mfma_f32_32x32x16_bf16 v[32:47], v[112:115], a[28:31], v[32:47]
    s_add_u32 m0, s26, 0
    ds_read_b64_tr_b16 v[96:97], v5 offset:0
    buffer_load_dwordx4 v8, s[12:15], s25 offen lds
    ds_read_b64_tr_b16 v[98:99], v5 offset:1024
    ds_read_b64_tr_b16 v[100:101], v6 offset:0
    v_mfma_f32_32x32x16_bf16 v[48:63], v[116:119], a[28:31], v[48:63]
    ds_read_b64_tr_b16 v[102:103], v6 offset:1024
    ds_read_b64_tr_b16 v[104:105], v5 offset:8192
    ds_read_b64_tr_b16 v[106:107], v5 offset:9216
    v_mfma_f32_32x32x16_bf16 v[64:79], v[120:123], a[28:31], v[64:79]
    s_add_u32 m0, s26, 1024
    ds_read_b64_tr_b16 v[108:109], v6 offset:8192
    buffer_load_dwordx4 v9, s[12:15], s25 offen lds
    ds_read_b64_tr_b16 v[110:111], v6 offset:9216
    v_mfma_f32_32x32x16_bf16 v[80:95], v[124:127], a[28:31], v[80:95]
    s_add_u32 m0, s26, 8192
    s_nop 0
    buffer_load_dwordx4 v10, s[12:15], s25 offen lds
    s_waitcnt lgkmcnt(0)
    v_mfma_f32_32x32x16_bf16 v[32:47], v[96:99], a[32:35], v[32:47]
    ds_read_b64_tr_b16 v[112:113], v5 offset:2048
    ds_read_b64_tr_b16 v[114:115], v5 offset:3072
    ds_read_b64_tr_b16 v[116:117], v6 offset:2048
    v_mfma_f32_32x32x16_bf16 v[48:63], v[100:103], a[32:35], v[48:63]
    s_add_u32 m0, s26, 9216
    ds_read_b64_tr_b16 v[118:119], v6 offset:3072
    buffer_load_dwordx4 v11, s[12:15], s25 offen lds
    ds_read_b64_tr_b16 v[120:121], v5 offset:10240
    ds_read_b64_tr_b16 v[122:123], v5 offset:11264
    v_mfma_f32_32x32x16_bf16 v[64:79], v[104:107], a[32:35], v[64:79]
    ds_read_b64_tr_b16 v[124:125], v6 offset:10240
    ds_read_b64_tr_b16 v[126:127], v6 offset:11264
    v_mfma_f32_32x32x16_bf16 v[80:95], v[108:111], a[32:35], v[80:95]
    buffer_load_dwordx4 a[0:3], v2, s[8:11], s24 offen offset:0 sc1
    s_waitcnt lgkmcnt(0)
    v_mfma_f32_32x32x16_bf16 v[32:47], v[112:115], a[36:39], v[32:47]
    ds_read_b64_tr_b16 v[96:97], v5 offset:4096
    ds_read_b64_tr_b16 v[98:99], v5 offset:5120
    ds_read_b64_tr_b16 v[100:101], v6 offset:4096
    buffer_load_dwordx4 a[4:7], v2, s[8:11], s24 offen offset:1024 sc1
    v_mfma_f32_32x32x16_bf16 v[48:63], v[116:119], a[36:39], v[48:63]
    ds_read_b64_tr_b16 v[102:103], v6 offset:5120
    ds_read_b64_tr_b16 v[104:105], v5 offset:12288
    ds_read_b64_tr_b16 v[106:107], v5 offset:13312
    v_mfma_f32_32x32x16_bf16 v[64:79], v[120:123], a[36:39], v[64:79]
    ds_read_b64_tr_b16 v[108:109], v6 offset:12288
    ds_read_b64_tr_b16 v[110:111], v6 offset:13312
    buffer_load_dwordx4 a[8:11], v2, s[8:11], s24 offen offset:2048 sc1
    v_mfma_f32_32x32x16_bf16 v[80:95], v[124:127], a[36:39], v[80:95]
    buffer_load_dwordx4 a[12:15], v2, s[8:11], s24 offen offset:3072 sc1
    s_waitcnt lgkmcnt(0)
    v_mfma_f32_32x32x16_bf16 v[32:47], v[96:99], a[40:43], v[32:47]
    ds_read_b64_tr_b16 v[112:113], v5 offset:6144
    ds_read_b64_tr_b16 v[114:115], v5 offset:7168
    ds_read_b64_tr_b16 v[116:117], v6 offset:6144
    v_mfma_f32_32x32x16_bf16 v[48:63], v[100:103], a[40:43], v[48:63]
    ds_read_b64_tr_b16 v[118:119], v6 offset:7168
    ds_read_b64_tr_b16 v[120:121], v5 offset:14336
    ds_read_b64_tr_b16 v[122:123], v5 offset:15360
    v_mfma_f32_32x32x16_bf16 v[64:79], v[104:107], a[40:43], v[64:79]
    ds_read_b64_tr_b16 v[124:125], v6 offset:14336
    ds_read_b64_tr_b16 v[126:127], v6 offset:15360
    v_mfma_f32_32x32x16_bf16 v[80:95], v[108:111], a[40:43], v[80:95]
    s_add_u32 s24, s24, 4096
    s_add_u32 s25, s25, 131072
    s_waitcnt lgkmcnt(0)
    s_waitcnt vmcnt(8)
    s_barrier
    v_add_u32 v5, 49152, v3
    v_add_u32 v6, 49152, v4
    v_mfma_f32_32x32x16_bf16 v[32:47], v[112:115], a[44:47], v[32:47]
    s_add_u32 m0, s26, 16384
    ds_read_b64_tr_b16 v[96:97], v5 offset:0
    buffer_load_dwordx4 v8, s[12:15], s25 offen lds
    ds_read_b64_tr_b16 v[98:99], v5 offset:1024
    ds_read_b64_tr_b16 v[100:101], v6 offset:0
    v_mfma_f32_32x32x16_bf16 v[48:63], v[116:119], a[44:47], v[48:63]
    ds_read_b64_tr_b16 v[102:103], v6 offset:1024
    ds_read_b64_tr_b16 v[104:105], v5 offset:8192
    ds_read_b64_tr_b16 v[106:107], v5 offset:9216
    v_mfma_f32_32x32x16_bf16 v[64:79], v[120:123], a[44:47], v[64:79]
    s_add_u32 m0, s26, 17408
    ds_read_b64_tr_b16 v[108:109], v6 offset:8192
    buffer_load_dwordx4 v9, s[12:15], s25 offen lds
    ds_read_b64_tr_b16 v[110:111], v6 offset:9216
    v_mfma_f32_32x32x16_bf16 v[80:95], v[124:127], a[44:47], v[80:95]
    s_add_u32 m0, s26, 24576
    s_nop 0
    buffer_load_dwordx4 v10, s[12:15], s25 offen lds
    s_waitcnt lgkmcnt(0)
    v_mfma_f32_32x32x16_bf16 v[32:47], v[96:99], a[48:51], v[32:47]
    ds_read_b64_tr_b16 v[112:113], v5 offset:2048
    ds_read_b64_tr_b16 v[114:115], v5 offset:3072
    ds_read_b64_tr_b16 v[116:117], v6 offset:2048
    v_mfma_f32_32x32x16_bf16 v[48:63], v[100:103], a[48:51], v[48:63]
    s_add_u32 m0, s26, 25600
    ds_read_b64_tr_b16 v[118:119], v6 offset:3072
    buffer_load_dwordx4 v11, s[12:15], s25 offen lds
    ds_read_b64_tr_b16 v[120:121], v5 offset:10240
    ds_read_b64_tr_b16 v[122:123], v5 offset:11264
    v_mfma_f32_32x32x16_bf16 v[64:79], v[104:107], a[48:51], v[64:79]
    ds_read_b64_tr_b16 v[124:125], v6 offset:10240
    ds_read_b64_tr_b16 v[126:127], v6 offset:11264
    v_mfma_f32_32x32x16_bf16 v[80:95], v[108:111], a[48:51], v[80:95]
    buffer_load_dwordx4 a[16:19], v2, s[8:11], s24 offen offset:0 sc1
    s_waitcnt lgkmcnt(0)
    v_mfma_f32_32x32x16_bf16 v[32:47], v[112:115], a[52:55], v[32:47]
    ds_read_b64_tr_b16 v[96:97], v5 offset:4096
    ds_read_b64_tr_b16 v[98:99], v5 offset:5120
    ds_read_b64_tr_b16 v[100:101], v6 offset:4096
    buffer_load_dwordx4 a[20:23], v2, s[8:11], s24 offen offset:1024 sc1
    v_mfma_f32_32x32x16_bf16 v[48:63], v[116:119], a[52:55], v[48:63]
    ds_read_b64_tr_b16 v[102:103], v6 offset:5120
    ds_read_b64_tr_b16 v[104:105], v5 offset:12288
    ds_read_b64_tr_b16 v[106:107], v5 offset:13312
    v_mfma_f32_32x32x16_bf16 v[64:79], v[120:123], a[52:55], v[64:79]
    ds_read_b64_tr_b16 v[108:109], v6 offset:12288
    ds_read_b64_tr_b16 v[110:111], v6 offset:13312
    buffer_load_dwordx4 a[24:27], v2, s[8:11], s24 offen offset:2048 sc1
    v_mfma_f32_32x32x16_bf16 v[80:95], v[124:127], a[52:55], v[80:95]
    buffer_load_dwordx4 a[28:31], v2, s[8:11], s24 offen offset:3072 sc1
    s_waitcnt lgkmcnt(0)
    v_mfma_f32_32x32x16_bf16 v[32:47], v[96:99], a[56:59], v[32:47]
    ds_read_b64_tr_b16 v[112:113], v5 offset:6144
    ds_read_b64_tr_b16 v[114:115], v5 offset:7168
    ds_read_b64_tr_b16 v[116:117], v6 offset:6144
    v_mfma_f32_32x32x16_bf16 v[48:63], v[100:103], a[56:59], v[48:63]
    ds_read_b64_tr_b16 v[118:119], v6 offset:7168
    ds_read_b64_tr_b16 v[120:121], v5 offset:14336
    ds_read_b64_tr_b16 v[122:123], v5 offset:15360
    v_mfma_f32_32x32x16_bf16 v[64:79], v[104:107], a[56:59], v[64:79]
    ds_read_b64_tr_b16 v[124:125], v6 offset:14336
    ds_read_b64_tr_b16 v[126:127], v6 offset:15360
    v_mfma_f32_32x32x16_bf16 v[80:95], v[108:111], a[56:59], v[80:95]
    s_add_u32 s24, s24, 4096
    s_add_u32 s25, s25, 131072
    s_waitcnt lgkmcnt(0)
    s_waitcnt vmcnt(8)
    s_barrier
    v_add_u32 v5, 0, v3
    v_add_u32 v6, 0, v4
    v_mfma_f32_32x32x16_bf16 v[32:47], v[112:115], a[60:63], v[32:47]
    s_add_u32 m0, s26, 32768
    ds_read_b64_tr_b16 v[96:97], v5 offset:0
    buffer_load_dwordx4 v8, s[12:15], s25 offen lds
    ds_read_b64_tr_b16 v[98:99], v5 offset:1024
    ds_read_b64_tr_b16 v[100:101], v6 offset:0
    v_mfma_f32_32x32x16_bf16 v[48:63], v[116:119], a[60:63], v[48:63]
    ds_read_b64_tr_b16 v[102:103], v6 offset:1024
    ds_read_b64_tr_b16 v[104:105], v5 offset:8192
    ds_read_b64_tr_b16 v[106:107], v5 offset:9216
    v_mfma_f32_32x32x16_bf16 v[64:79], v[120:123], a[60:63], v[64:79]
    s_add_u32 m0, s26, 33792
    ds_read_b64_tr_b16 v[108:109], v6 offset:8192
    buffer_load_dwordx4 v9, s[12:15], s25 offen lds
    ds_read_b64_tr_b16 v[110:111], v6 offset:9216
    v_mfma_f32_32x32x16_bf16 v[80:95], v[124:127], a[60:63], v[80:95]
    s_add_u32 m0, s26, 40960
    s_nop 0
    buffer_load_dwordx4 v10, s[12:15], s25 offen lds
    s_sub_u32 s27, s27, 1
    s_cmp_lg_u32 s27, 0
    s_cbranch_scc1 LOOP_48
    s_waitcnt vmcnt(0) lgkmcnt(0)
    s_nop 7
    s_lshl_b32 s16, s2, 15
    s_lshl_b32 s17, s22, 13
    s_add_u32 s16, s16, s17
    s_add_u32 s48, s4, s16
    s_addc_u32 s49, s5, 0
    s_add_u32 s48, s48, 50331648
    s_addc_u32 s49, s49, 0
    s_and_b32 s49, s49, 0xffff
    s_mov_b32 s50, 8192
    s_mov_b32 s51, 0x20000
    s_mov_b32 s39, 4096
    s_cmp_eq_u32 s36, 0
    s_cbranch_scc0 KEEP1_53
    buffer_store_dwordx4 v[64:67], v2, s[48:51], 0 offen offset:0 sc1
    buffer_store_dwordx4 v[68:71], v2, s[48:51], 0 offen offset:1024 sc1
    buffer_store_dwordx4 v[72:75], v2, s[48:51], 0 offen offset:2048 sc1
    buffer_store_dwordx4 v[76:79], v2, s[48:51], 0 offen offset:3072 sc1
    buffer_store_dwordx4 v[80:83], v2, s[48:51], s39 offen offset:0 sc1
    buffer_store_dwordx4 v[84:87], v2, s[48:51], s39 offen offset:1024 sc1
    buffer_store_dwordx4 v[88:91], v2, s[48:51], s39 offen offset:2048 sc1
    buffer_store_dwordx4 v[92:95], v2, s[48:51], s39 offen offset:3072 sc1
    s_branch SENT_54
KEEP1_53:
    buffer_store_dwordx4 v[32:35], v2, s[48:51], 0 offen offset:0 sc1
    buffer_store_dwordx4 v[36:39], v2, s[48:51], 0 offen offset:1024 sc1
    buffer_store_dwordx4 v[40:43], v2, s[48:51], 0 offen offset:2048 sc1
    buffer_store_dwordx4 v[44:47], v2, s[48:51], 0 offen offset:3072 sc1
    buffer_store_dwordx4 v[48:51], v2, s[48:51], s39 offen offset:0 sc1
    buffer_store_dwordx4 v[52:55], v2, s[48:51], s39 offen offset:1024 sc1
    buffer_store_dwordx4 v[56:59], v2, s[48:51], s39 offen offset:2048 sc1
    buffer_store_dwordx4 v[60:63], v2, s[48:51], s39 offen offset:3072 sc1
    s_nop 1
    v_mov_b32 v32, v64
    v_mov_b32 v33, v65
    v_mov_b32 v34, v66
    v_mov_b32 v35, v67
    v_mov_b32 v36, v68
    v_mov_b32 v37, v69
    v_mov_b32 v38, v70
    v_mov_b32 v39, v71
    v_mov_b32 v40, v72
    v_mov_b32 v41, v73
    v_mov_b32 v42, v74
    v_mov_b32 v43, v75
    v_mov_b32 v44, v76
    v_mov_b32 v45, v77
    v_mov_b32 v46, v78
    v_mov_b32 v47, v79
    v_mov_b32 v48, v80
    v_mov_b32 v49, v81
    v_mov_b32 v50, v82
    v_mov_b32 v51, v83
    v_mov_b32 v52, v84
    v_mov_b32 v53, v85
    v_mov_b32 v54, v86
    v_mov_b32 v55, v87
    v_mov_b32 v56, v88
    v_mov_b32 v57, v89
    v_mov_b32 v58, v90
    v_mov_b32 v59, v91
    v_mov_b32 v60, v92
    v_mov_b32 v61, v93
    v_mov_b32 v62, v94
    v_mov_b32 v63, v95
SENT_54:
    s_xor_b32 s38, s2, 1
    s_lshl_b32 s16, s38, 15
    s_add_u32 s16, s16, s17
    s_add_u32 s52, s4, s16
    s_addc_u32 s53, s5, 0
    s_add_u32 s52, s52, 50331648
    s_addc_u32 s53, s53, 0
    s_and_b32 s53, s53, 0xffff
    s_mov_b32 s54, 8192
    s_mov_b32 s55, 0x20000
    s_add_u32 s56, s4, 655360
    s_addc_u32 s57, s5, 0
    s_and_b32 s57, s57, 0xffff
    s_mov_b32 s58, 32768
    s_mov_b32 s59, 0x20000
    s_lshl_b32 s17, s22, 2
    s_lshl_b32 s16, s2, 7
    s_add_u32 s16, s16, s17
    v_mov_b32 v24, 1
    v_mov_b32 v25, s16
    s_lshl_b32 s16, s38, 7
    s_add_u32 s16, s16, s17
    v_mov_b32 v26, s16
    s_waitcnt vmcnt(0)
    s_mov_b64 exec, 1
    buffer_store_dword v24, v25, s[56:59], 0 offen sc1
    s_mov_b64 exec, -1
    v_lshlrev_b32 v16, 2, v0
    v_add_u32 v16, 65536, v16
    v_cmp_gt_u32 vcc, 64, v0
    v_lshrrev_b32 v17, 5, v1
    s_and_saveexec_b64 s[74:75], vcc
    ds_write_b32 v16, v144
    s_mov_b64 exec, s[74:75]
    v_lshlrev_b32 v17, 4, v17
    v_add_u32 v17, 65536, v17
    s_waitcnt lgkmcnt(0)
    s_barrier
    ds_read_b128 v[148:151], v17 offset:0
    ds_read_b128 v[152:155], v17 offset:32
    ds_read_b128 v[156:159], v17 offset:64
    ds_read_b128 v[160:163], v17 offset:96
    ds_read_b128 v[164:167], v17 offset:128
    ds_read_b128 v[168:171], v17 offset:160
    ds_read_b128 v[172:175], v17 offset:192
    ds_read_b128 v[176:179], v17 offset:224
    s_mov_b64 exec, 1
    s_mov_b32 s16, 0x8000
POLL_55:
    buffer_load_dword v27, v26, s[56:59], 0 offen sc1
    s_waitcnt vmcnt(0)
    v_readfirstlane_b32 s17, v27
    s_sub_u32 s16, s16, 1
    s_cmp_eq_u32 s16, 0
    s_cbranch_scc1 GOT_56
    s_cmp_eq_u32 s17, 1
    s_cbranch_scc0 POLL_55
GOT_56:
    s_mov_b64 exec, -1
    buffer_load_dwordx4 v[64:67], v2, s[52:55], 0 offen offset:0 sc1
    buffer_load_dwordx4 v[68:71], v2, s[52:55], 0 offen offset:1024 sc1
    buffer_load_dwordx4 v[72:75], v2, s[52:55], 0 offen offset:2048 sc1
    buffer_load_dwordx4 v[76:79], v2, s[52:55], 0 offen offset:3072 sc1
    buffer_load_dwordx4 v[80:83], v2, s[52:55], s39 offen offset:0 sc1
    buffer_load_dwordx4 v[84:87], v2, s[52:55], s39 offen offset:1024 sc1
    buffer_load_dwordx4 v[88:91], v2, s[52:55], s39 offen offset:2048 sc1
    buffer_load_dwordx4 v[92:95], v2, s[52:55], s39 offen offset:3072 sc1
    s_waitcnt vmcnt(7)
    v_pk_add_f32 v[32:33], v[32:33], v[64:65]
    v_pk_add_f32 v[34:35], v[34:35], v[66:67]
    s_waitcnt vmcnt(6)
    v_pk_add_f32 v[36:37], v[36:37], v[68:69]
    v_pk_add_f32 v[38:39], v[38:39], v[70:71]
    s_waitcnt vmcnt(5)
    v_pk_add_f32 v[40:41], v[40:41], v[72:73]
    v_pk_add_f32 v[42:43], v[42:43], v[74:75]
    s_waitcnt vmcnt(4)
    v_pk_add_f32 v[44:45], v[44:45], v[76:77]
    v_pk_add_f32 v[46:47], v[46:47], v[78:79]
    s_waitcnt vmcnt(3)
    v_pk_add_f32 v[48:49], v[48:49], v[80:81]
    v_pk_add_f32 v[50:51], v[50:51], v[82:83]
    s_waitcnt vmcnt(2)
    v_pk_add_f32 v[52:53], v[52:53], v[84:85]
    v_pk_add_f32 v[54:55], v[54:55], v[86:87]
    s_waitcnt vmcnt(1)
    v_pk_add_f32 v[56:57], v[56:57], v[88:89]
    v_pk_add_f32 v[58:59], v[58:59], v[90:91]
    s_waitcnt vmcnt(0)
    v_pk_add_f32 v[60:61], v[60:61], v[92:93]
    v_pk_add_f32 v[62:63], v[62:63], v[94:95]
    s_waitcnt lgkmcnt(0)
    s_mov_b32 s21, s37
    v_lshlrev_b32 v18, 16, v128
    v_and_b32 v19, s30, v128
    v_pk_fma_f32 v[32:33], v[32:33], v[148:149], v[18:19]
    v_cvt_pk_bf16_f32 v96, v32, v33
    v_lshlrev_b32 v20, 16, v129
    v_and_b32 v21, s30, v129
    v_pk_fma_f32 v[34:35], v[34:35], v[150:151], v[20:21]
    v_cvt_pk_bf16_f32 v97, v34, v35
    v_lshlrev_b32 v18, 16, v130
    v_and_b32 v19, s30, v130
    v_pk_fma_f32 v[36:37], v[36:37], v[152:153], v[18:19]
    v_cvt_pk_bf16_f32 v98, v36, v37
    v_lshlrev_b32 v20, 16, v131
    v_and_b32 v21, s30, v131
    v_pk_fma_f32 v[38:39], v[38:39], v[154:155], v[20:21]
    v_cvt_pk_bf16_f32 v99, v38, v39
    v_lshlrev_b32 v18, 16, v132
    v_and_b32 v19, s30, v132
    v_pk_fma_f32 v[40:41], v[40:41], v[156:157], v[18:19]
    v_cvt_pk_bf16_f32 v100, v40, v41
    v_lshlrev_b32 v20, 16, v133
    v_and_b32 v21, s30, v133
    v_pk_fma_f32 v[42:43], v[42:43], v[158:159], v[20:21]
    v_cvt_pk_bf16_f32 v101, v42, v43
    v_lshlrev_b32 v18, 16, v134
    v_and_b32 v19, s30, v134
    v_pk_fma_f32 v[44:45], v[44:45], v[160:161], v[18:19]
    v_cvt_pk_bf16_f32 v102, v44, v45
    v_lshlrev_b32 v20, 16, v135
    v_and_b32 v21, s30, v135
    v_pk_fma_f32 v[46:47], v[46:47], v[162:163], v[20:21]
    v_cvt_pk_bf16_f32 v103, v46, v47
    v_lshlrev_b32 v18, 16, v136
    v_and_b32 v19, s30, v136
    v_pk_fma_f32 v[48:49], v[48:49], v[164:165], v[18:19]
    v_cvt_pk_bf16_f32 v104, v48, v49
    v_lshlrev_b32 v20, 16, v137
    v_and_b32 v21, s30, v137
    v_pk_fma_f32 v[50:51], v[50:51], v[166:167], v[20:21]
    v_cvt_pk_bf16_f32 v105, v50, v51
    v_lshlrev_b32 v18, 16, v138
    v_and_b32 v19, s30, v138
    v_pk_fma_f32 v[52:53], v[52:53], v[168:169], v[18:19]
    v_cvt_pk_bf16_f32 v106, v52, v53
    v_lshlrev_b32 v20, 16, v139
    v_and_b32 v21, s30, v139
    v_pk_fma_f32 v[54:55], v[54:55], v[170:171], v[20:21]
    v_cvt_pk_bf16_f32 v107, v54, v55
    v_lshlrev_b32 v18, 16, v140
    v_and_b32 v19, s30, v140
    v_pk_fma_f32 v[56:57], v[56:57], v[172:173], v[18:19]
    v_cvt_pk_bf16_f32 v108, v56, v57
    v_lshlrev_b32 v20, 16, v141
    v_and_b32 v21, s30, v141
    v_pk_fma_f32 v[58:59], v[58:59], v[174:175], v[20:21]
    v_cvt_pk_bf16_f32 v109, v58, v59
    v_lshlrev_b32 v18, 16, v142
    v_and_b32 v19, s30, v142
    v_pk_fma_f32 v[60:61], v[60:61], v[176:177], v[18:19]
    v_cvt_pk_bf16_f32 v110, v60, v61
    v_lshlrev_b32 v20, 16, v143
    v_and_b32 v21, s30, v143
    v_pk_fma_f32 v[62:63], v[62:63], v[178:179], v[20:21]
    v_cvt_pk_bf16_f32 v111, v62, v63
    s_mov_b32 s40, s34
    s_and_b32 s41, s35, 0xffff
    s_mov_b32 s42, 4194304
    s_mov_b32 s43, 0x20000
    v_and_b32 v22, 31, v1
    v_lshlrev_b32 v22, 11, v22
    v_lshrrev_b32 v23, 5, v1
    v_lshlrev_b32 v23, 4, v23
    v_add_u32 v22, v22, v23
    s_lshl_b32 s16, s23, 16
    s_lshl_b32 s17, s21, 7
    s_add_u32 s16, s16, s17
    v_permlane32_swap_b32 v96, v98
    v_permlane32_swap_b32 v97, v99
    s_nop 0
    buffer_store_dwordx4 v[96:99], v22, s[40:43], s16 offen offset:0
    v_permlane32_swap_b32 v100, v102
    v_permlane32_swap_b32 v101, v103
    s_nop 0
    buffer_store_dwordx4 v[100:103], v22, s[40:43], s16 offen offset:32
    v_permlane32_swap_b32 v104, v106
    v_permlane32_swap_b32 v105, v107
    s_nop 0
    buffer_store_dwordx4 v[104:107], v22, s[40:43], s16 offen offset:64
    v_permlane32_swap_b32 v108, v110
    v_permlane32_swap_b32 v109, v111
    s_nop 0
    buffer_store_dwordx4 v[108:111], v22, s[40:43], s16 offen offset:96
END_16:
    s_endpgm
CODE_END:
    s_endpgm
.section .rodata,"a"
.p2align 6
.amdhsa_kernel mod_kernel
  .amdhsa_next_free_vgpr 128
  .amdhsa_next_free_sgpr 102
  .amdhsa_accum_offset 128
  .amdhsa_group_segment_fixed_size 0
  .amdhsa_kernarg_size 88
  .amdhsa_user_sgpr_count 2
  .amdhsa_user_sgpr_kernarg_segment_ptr 1
  .amdhsa_system_sgpr_workgroup_id_x 1
.end_amdhsa_kernel
.p2align 6
.amdhsa_kernel lnq_kernel
  .amdhsa_next_free_vgpr 320
  .amdhsa_next_free_sgpr 102
  .amdhsa_accum_offset 256
  .amdhsa_group_segment_fixed_size 0
  .amdhsa_kernarg_size 88
  .amdhsa_user_sgpr_count 2
  .amdhsa_user_sgpr_kernarg_segment_ptr 1
  .amdhsa_system_sgpr_workgroup_id_x 1
.end_amdhsa_kernel
.p2align 6
.amdhsa_kernel amega_kernel
  .amdhsa_next_free_vgpr 384
  .amdhsa_next_free_sgpr 102
  .amdhsa_accum_offset 256
  .amdhsa_group_segment_fixed_size 0
  .amdhsa_kernarg_size 88
  .amdhsa_user_sgpr_count 2
  .amdhsa_user_sgpr_kernarg_segment_ptr 1
  .amdhsa_system_sgpr_workgroup_id_x 1
.end_amdhsa_kernel
```
